```python
import torch

def _softmax(x, axis=-1):
    return torch.softmax(x, dim=axis)

def _gelu(x):
    return torch.nn.functional.gelu(x, approximate='tanh')

def _silu(x):
    return torch.nn.functional.silu(x)

def _sigmoid(x):
    return torch.sigmoid(x)

def _layernorm(x, axis=-1, eps=1e-05):
    m = x.mean(dim=axis, keepdim=True)
    v = x.var(dim=axis, keepdim=True, unbiased=False)
    return (x - m) / torch.sqrt(v + eps)

def _scatter_add(tgt, idx, src, axis=0):
    return tgt.clone().index_add_(axis, idx, src)

def _segment_sum(src, seg, n):
    out = torch.zeros((n,) + src.shape[1:], dtype=src.dtype)
    return out.index_add_(0, seg, src)

def _pad(x, pw):
    flat = tuple((v for pair in reversed(pw) for v in pair))
    return torch.nn.functional.pad(x, flat)
kernel_name = 'parallel_sum__softmax_full_mha__mixer_gmlp__prompt'

def setup_inputs():

    _w = lambda a: (lambda t: t.to(torch.bfloat16) if t.is_floating_point() else t)(torch.as_tensor(a))

    def _A_setup():
        B, S, D = (1, 2048, 512)
        return {'x': _w((lambda *s: torch.randn(*s, dtype=torch.bfloat16) * 0.05)(B, S, D)), 'wqkv': _w((lambda *s: torch.randn(*s, dtype=torch.bfloat16) * 0.2)(D, 3 * D)), 'wo': _w((lambda *s: torch.randn(*s, dtype=torch.bfloat16) * 0.1)(D, D))}
    _A_in = _A_setup()

    def _B_setup():
        B, S, D, F = (1, 2048, 512, 1376)
        Fh = F // 2
        return {'x': _w((lambda *s: torch.randn(*s, dtype=torch.bfloat16) * 0.05)(B, S, D)), 'w_in': _w((lambda *s: torch.randn(*s, dtype=torch.bfloat16) * 0.8)(D, 2 * Fh)), 'w_sp': _w(0.01 * (lambda *s: torch.randn(*s, dtype=torch.bfloat16) * 0.8)(S, S)), 'b_sp': _w(1.0 + 0.01 * (lambda *s: torch.randn(*s, dtype=torch.bfloat16) * 0.1)(S)), 'w_out': _w((lambda *s: torch.randn(*s, dtype=torch.bfloat16) * 0.1)(Fh, D))}
    _B_in = _B_setup()
    return {'A_x': _A_in['x'], 'A_wqkv': _A_in['wqkv'], 'A_wo': _A_in['wo'], 'B_x': _B_in['x'], 'B_w_in': _B_in['w_in'], 'B_w_sp': _B_in['w_sp'], 'B_b_sp': _B_in['b_sp'], 'B_w_out': _B_in['w_out']}

def reference(A_x, A_wqkv, A_wo, B_x, B_w_in, B_w_sp, B_b_sp, B_w_out):

    def _A_ref(x, wqkv, wo):
        B, S, D = x.shape
        H = 32
        Dh = D // H
        qkv = (lambda x, *d: x.permute(*d))((x @ wqkv).reshape(B, S, 3, H, Dh), 2, 0, 3, 1, 4)
        q, k, v = (qkv[0], qkv[1], qkv[2])
        scale = Dh ** (-0.5)
        scores = torch.einsum('bhqd,bhkd->bhqk', q, k) * scale
        p = _softmax(scores, axis=-1)
        o = torch.einsum('bhqk,bhkd->bhqd', p, v)
        return (lambda x, *d: x.permute(*d))(o, 0, 2, 1, 3).reshape(B, S, D) @ wo

    def _B_ref(x, w_in, w_sp, b_sp, w_out):
        B, S, D = x.shape
        F = w_in.shape[-1]
        Fh = F // 2
        z = _gelu(torch.einsum('bsd,df->bsf', x, w_in))
        z1 = z[..., :Fh].clone()
        z2 = _layernorm(z[..., Fh:], axis=-1)
        g = torch.einsum('ts,bsf->btf', w_sp, z2) + b_sp[None, :, None]
        return torch.einsum('bsf,fd->bsd', z1 * g, w_out)
    x = A_x
    xn = _layernorm(x, axis=-1)
    return x + _A_ref(xn, A_wqkv, A_wo) + _B_ref(xn, B_w_in, B_w_sp, B_b_sp, B_w_out)
```

```asm
; @launch grid=(256,1,1) block=(768,1,1) lds=163840
.amdgcn_target "amdgcn-amd-amdhsa--gfx950"
.text
.globl parallel_sum__softmax_full_mha__mixer_gmlp__prompt_kernel
.p2align 8
.type parallel_sum__softmax_full_mha__mixer_gmlp__prompt_kernel,@function
parallel_sum__softmax_full_mha__mixer_gmlp__prompt_kernel:
    s_cmp_ge_u32 s2, 256
    s_cbranch_scc1 K1_exit
    s_load_dwordx4 s[24:27], s[0:1], 0
    s_load_dwordx2 s[28:29], s[0:1], 32
    s_load_dwordx4 s[48:51], s[0:1], 72
    v_lshrrev_b32 v1, 6, v0
    v_and_b32 v2, 63, v0
    v_readfirstlane_b32 s16, v1
    s_bfe_u32 s17, s2, 0x20001
    s_bfe_u32 s18, s2, 0x20003
    s_lshl_b32 s18, s18, 2
    s_or_b32 s17, s17, s18
    s_and_b32 s18, s2, 1
    s_lshl_b32 s18, s18, 3
    s_lshr_b32 s20, s2, 5
    s_or_b32 s18, s18, s20
    s_cmp_lt_u32 s17, 11
    s_cselect_b32 s19, 1, 0
    s_mov_b32 s63, 200000
    s_cmp_ge_u32 s16, 8
    s_cbranch_scc0 K1_compute
    s_setprio 2
    s_sub_u32 s16, s16, 8
    s_cmp_eq_u32 s19, 1
    s_mov_b32 s20, 3072
    s_cmov_b32 s20, 2752
    s_lshl_b32 s21, s17, 7
    s_add_u32 s22, s21, 1344
    s_add_u32 s23, s21, 640
    s_min_u32 s32, s17, 13
    s_lshl_b32 s32, s32, 7
    s_add_u32 s32, s32, 1280
    s_cmp_eq_u32 s19, 1
    s_cselect_b32 s22, s22, s23
    s_cselect_b32 s23, s21, s32
    v_lshrrev_b32 v3, 4, v2
    s_and_b32 s33, s16, 1
    s_lshl_b32 s33, s33, 2
    v_add_u32 v3, s33, v3
    v_and_b32 v8, 7, v2
    v_xor_b32 v3, v3, v8
    v_lshlrev_b32 v3, 4, v3
    v_lshrrev_b32 v9, 3, v2
    s_lshl_b32 s34, s18, 7
    s_lshl_b32 s35, s16, 3
    s_add_u32 s34, s34, s35
    v_add_u32 v4, s34, v9
    v_lshlrev_b32 v4, 10, v4
    v_add_u32 v4, v4, v3
    v_add_u32 v5, 32768, v4
    v_add_u32 v6, 65536, v4
    v_add_u32 v7, 98304, v4
    v_bfe_u32 v3, v2, 4, 1
    v_lshlrev_b32 v3, 2, v3
    v_xor_b32 v3, v3, v8
    v_lshlrev_b32 v3, 4, v3
    v_add_u32 v16, s35, v9
    v_mul_u32_u24 v10, 3072, v16
    v_add3_u32 v10, v10, v3, s21
    v_add_u32 v11, 32*3072, v10
    v_mul_lo_u32 v16, v16, s20
    v_add_u32 v16, v16, v3
    v_add_u32 v12, s22, v16
    v_add_u32 v14, s23, v16
    s_lshl_b32 s36, s20, 5
    v_add_u32 v13, s36, v12
    v_add_u32 v15, s36, v14
    s_lshl_b32 s37, s20, 6
    s_add_u32 s47, s18, s17
    s_and_b32 s47, s47, 7
    s_lshl_b32 s38, s47, 7
    s_mul_i32 s39, s47, 196608
    s_mul_i32 s43, s47, s37
    s_lshl_b32 s40, s16, 10
    s_add_u32 s40, s40, 40960
    s_mov_b32 s41, 0
    s_waitcnt lgkmcnt(0)
    s_mov_b32 s4, s24
    s_and_b32 s5, s25, 0xffff
    s_mov_b32 s6, 2097152
    s_mov_b32 s7, 0x00020000
    s_mov_b32 s8, s26
    s_and_b32 s9, s27, 0xffff
    s_mov_b32 s10, 1572864
    s_mov_b32 s11, 0x00020000
    s_cmp_eq_u32 s19, 1
    s_cselect_b32 s12, s28, s26
    s_cselect_b32 s13, s29, s27
    s_and_b32 s13, s13, 0xffff
    s_lshl_b32 s14, s20, 9
    s_mov_b32 s15, 0x00020000
    s_add_u32 m0, s40, 0
    s_nop 0
    buffer_load_dwordx4 v4, s[4:7], s38 offen lds
    s_add_u32 m0, s40, 16384
    s_nop 0
    buffer_load_dwordx4 v10, s[8:11], s39 offen lds
    s_add_u32 m0, s40, 20480
    s_nop 0
    buffer_load_dwordx4 v11, s[8:11], s39 offen lds
    s_add_u32 m0, s40, 4096
    s_nop 0
    buffer_load_dwordx4 v5, s[4:7], s38 offen lds
    s_add_u32 m0, s40, 24576
    s_nop 0
    buffer_load_dwordx4 v12, s[12:15], s43 offen lds
    s_add_u32 m0, s40, 28672
    s_nop 0
    buffer_load_dwordx4 v13, s[12:15], s43 offen lds
    s_add_u32 m0, s40, 8192
    s_nop 0
    buffer_load_dwordx4 v6, s[4:7], s38 offen lds
    s_add_u32 m0, s40, 32768
    s_nop 0
    buffer_load_dwordx4 v14, s[12:15], s43 offen lds
    s_add_u32 m0, s40, 36864
    s_nop 0
    buffer_load_dwordx4 v15, s[12:15], s43 offen lds
    s_add_u32 m0, s40, 12288
    s_nop 0
    buffer_load_dwordx4 v7, s[4:7], s38 offen lds
    s_add_u32 s38, s38, 128
    s_add_u32 s39, s39, 196608
    s_add_u32 s43, s43, s37
    s_cmp_eq_u32 s38, 1024
    s_cmov_b32 s38, 0
    s_cmov_b32 s39, 0
    s_cmov_b32 s43, 0
    s_add_u32 s40, s40, 40960
    s_cmp_ge_u32 s40, 163840
    s_cselect_b32 s42, 163840, 0
    s_sub_u32 s40, s40, s42
    s_mov_b32 s41, 0
K1_steady:
    s_add_u32 m0, s40, 0
    s_nop 0
    buffer_load_dwordx4 v4, s[4:7], s38 offen lds
    s_add_u32 m0, s40, 16384
    s_nop 0
    buffer_load_dwordx4 v10, s[8:11], s39 offen lds
    s_add_u32 m0, s40, 20480
    s_nop 0
    buffer_load_dwordx4 v11, s[8:11], s39 offen lds
    s_add_u32 m0, s40, 4096
    s_nop 0
    buffer_load_dwordx4 v5, s[4:7], s38 offen lds
    s_add_u32 m0, s40, 24576
    s_nop 0
    buffer_load_dwordx4 v12, s[12:15], s43 offen lds
    s_add_u32 m0, s40, 28672
    s_nop 0
    buffer_load_dwordx4 v13, s[12:15], s43 offen lds
    s_add_u32 m0, s40, 8192
    s_nop 0
    buffer_load_dwordx4 v6, s[4:7], s38 offen lds
    s_add_u32 m0, s40, 32768
    s_nop 0
    buffer_load_dwordx4 v14, s[12:15], s43 offen lds
    s_waitcnt vmcnt(8)
    s_barrier
    s_add_u32 m0, s40, 36864
    s_nop 0
    buffer_load_dwordx4 v15, s[12:15], s43 offen lds
    s_add_u32 m0, s40, 12288
    s_nop 0
    buffer_load_dwordx4 v7, s[4:7], s38 offen lds
    s_add_u32 s38, s38, 128
    s_add_u32 s39, s39, 196608
    s_add_u32 s43, s43, s37
    s_cmp_eq_u32 s38, 1024
    s_cmov_b32 s38, 0
    s_cmov_b32 s39, 0
    s_cmov_b32 s43, 0
    s_add_u32 s40, s40, 40960
    s_cmp_ge_u32 s40, 163840
    s_cselect_b32 s42, 163840, 0
    s_sub_u32 s40, s40, s42
    s_add_u32 s41, s41, 1
    s_cmp_lt_u32 s41, 7
    s_cbranch_scc1 K1_steady
    s_mov_b32 s52, s16
    s_mov_b32 s8, s48
    s_and_b32 s9, s49, 0xffff
    s_mov_b32 s10, 256
    s_mov_b32 s11, 0x00020000
    s_mov_b32 s12, s50
    s_and_b32 s13, s51, 0xffff
    s_mov_b32 s14, 33554432
    s_mov_b32 s15, 0x00020000
    v_lshlrev_b32 v24, 2, v2
    v_add_u32 v25, 162816, v24
    v_mov_b32 v26, 0
    v_and_b32 v17, 31, v2
    v_lshrrev_b32 v18, 5, v2
    s_lshl_b32 s47, s16, 5
    v_add_u32 v17, s47, v17
    v_lshlrev_b32 v17, 2, v17
    v_lshlrev_b32 v6, 1, v17
    v_add_u32 v17, 136192, v17
    v_lshl_add_u32 v6, v18, 10, v6
    s_mul_i32 s42, s18, 22528
    s_add_u32 s42, s42, 9437184
    s_mov_b32 s44, 0x01010101
    s_waitcnt vmcnt(0)
    s_barrier
    s_setprio 3
    ds_write_b32 v25, v26
    s_cmp_eq_u32 s16, 0
    s_cbranch_scc0 K1_nl0
    buffer_load_dword v20, v24, s[8:11], 0 offen
K1_nl0:
    s_waitcnt lgkmcnt(0)
    s_barrier
    s_barrier
    s_cbranch_scc0 K1_nl1
K1_rdy:
    s_waitcnt vmcnt(0)
    v_cmp_ne_u32 vcc, s44, v20
    s_nop 0
    s_cbranch_vccz K1_rdy1
    s_sleep 16
    buffer_load_dword v20, v24, s[8:11], 0 offen sc1
    s_sub_u32 s63, s63, 1
    s_cbranch_scc0 K1_rdy
K1_rdy1:
    v_mov_b32 v21, 162928
    v_mov_b32 v22, 1
    ds_write_b32 v21, v22
K1_nl1:
    s_mov_b32 s55, s19
    v_bfe_u32 v7, v2, 2, 2
    v_lshl_add_u32 v7, v18, 3, v7
    v_add_u32 v7, s47, v7
    v_mul_u32_u24 v7, 136, v7
    v_bfe_u32 v8, v2, 4, 1
    v_lshl_add_u32 v7, v8, 5, v7
    v_and_b32 v8, 3, v2
    v_lshl_add_u32 v7, v8, 3, v7
    v_add_u32 v7, 145408, v7
    s_lshl_b32 s46, s16, 7
    s_add_u32 s46, s46, 136192
    v_lshl_add_u32 v9, v18, 5, s46
    s_lshl_b32 s34, s17, 1
    s_add_u32 s34, s34, 0
    s_mul_i32 s35, s34, 43
    s_lshr_b32 s35, s35, 7
    s_mul_i32 s33, s35, 3
    s_sub_u32 s33, s34, s33
    s_lshl_b32 s33, s33, 10
    s_mul_i32 s35, s35, 393216
    s_add_u32 s33, s33, s35
    s_lshl_b32 s34, s18, 2
    s_add_u32 s34, s34, s16
    s_mul_i32 s34, s34, 6144
    s_add_u32 s33, s33, s34
    s_add_u32 s40, s33, 12582912
    s_lshl_b32 s34, s17, 1
    s_add_u32 s34, s34, 1
    s_mul_i32 s35, s34, 43
    s_lshr_b32 s35, s35, 7
    s_mul_i32 s33, s35, 3
    s_sub_u32 s33, s34, s33
    s_lshl_b32 s33, s33, 10
    s_mul_i32 s35, s35, 393216
    s_add_u32 s33, s33, s35
    s_lshl_b32 s34, s18, 2
    s_add_u32 s34, s34, s16
    s_mul_i32 s34, s34, 6144
    s_add_u32 s33, s33, s34
    s_add_u32 s41, s33, 12582912
    s_lshl_b32 s43, s17, 7
    s_lshl_b32 s39, s18, 2
    s_add_u32 s43, s43, s39
    s_add_u32 s43, s43, 25182208
    s_branch M_gemm
K1_exit:
    s_endpgm
K1_compute:
    s_load_dwordx2 s[4:5], s[0:1], 40
    s_lshr_b32 s20, s16, 1
    s_and_b32 s21, s16, 1
    s_add_u32 s57, s20, 4
    s_and_b32 s58, s2, 7
    s_lshl_b32 s58, s58, 20
    s_lshr_b32 s59, s2, 3
    s_lshl_b32 s59, s59, 15
    s_add_u32 s58, s58, s59
    s_lshl_b32 s59, s16, 12
    s_add_u32 s58, s58, s59
    v_lshlrev_b32 v143, 7, v2
    s_xor_b32 s22, s20, s21
    v_and_b32 v3, 31, v2
    v_lshrrev_b32 v4, 5, v2
    v_bfe_u32 v5, v3, 1, 3
    v_xor_b32 v5, v5, v4
    v_lshlrev_b32 v5, 4, v5
    s_lshl_b32 s23, s22, 5
    v_xor_b32 v5, s23, v5
    s_lshl_b32 s23, s20, 5
    v_add_u32 v13, s23, v3
    v_lshl_add_u32 v112, v13, 7, v5
    v_add_u32 v112, 40960, v112
    v_xor_b32 v113, 32, v112
    v_xor_b32 v114, 64, v112
    v_xor_b32 v115, 96, v112
    v_bfe_u32 v5, v2, 2, 2
    v_lshl_add_u32 v6, v4, 3, v5
    v_lshlrev_b32 v6, 7, v6
    v_bfe_u32 v7, v2, 4, 1
    v_lshlrev_b32 v7, 1, v7
    v_bfe_u32 v15, v2, 1, 1
    v_add_u32 v7, v7, v15
    s_lshl_b32 s23, s21, 2
    v_add_u32 v7, s23, v7
    v_lshrrev_b32 v5, 1, v5
    v_lshlrev_b32 v5, 2, v5
    v_xor_b32 v7, v7, v5
    v_lshl_add_u32 v6, v7, 4, v6
    v_and_b32 v15, 1, v2
    v_lshl_add_u32 v6, v15, 3, v6
    s_lshl_b32 s23, s22, 11
    s_add_u32 s23, s23, 57344
    v_add_u32 v116, s23, v6
    v_xor_b32 v117, 2048, v116
    v_xor_b32 v118, 4096, v116
    v_xor_b32 v119, 6144, v116
    v_lshrrev_b32 v5, 1, v2
    v_xor_b32 v5, v5, v2
    v_bfe_u32 v5, v5, 3, 1
    v_add_u32 v5, -1, v5
    v_and_b32 v48, 0x3f803f80, v5
    v_mov_b32 v49, v48
    v_mov_b32 v50, v48
    v_mov_b32 v51, v48
    v_mov_b32 v52, 0
    v_mov_b32 v53, 0
    v_mov_b32 v54, 0
    v_mov_b32 v55, 0
    v_mov_b32 v56, 0
    v_mov_b32 v57, 0
    v_mov_b32 v58, 0
    v_mov_b32 v59, 0
    v_mov_b32 v60, 0
    v_mov_b32 v61, 0
    v_mov_b32 v62, 0
    v_mov_b32 v63, 0
    v_mov_b32 v64, 0
    v_mov_b32 v65, 0
    v_mov_b32 v66, 0
    v_mov_b32 v67, 0
    v_mov_b32 v68, 0
    v_mov_b32 v69, 0
    v_mov_b32 v70, 0
    v_mov_b32 v71, 0
    v_mov_b32 v72, 0
    v_mov_b32 v73, 0
    v_mov_b32 v74, 0
    v_mov_b32 v75, 0
    v_mov_b32 v76, 0
    v_mov_b32 v77, 0
    v_mov_b32 v78, 0
    v_mov_b32 v79, 0
    v_mov_b32 v80, 0
    v_mov_b32 v81, 0
    v_mov_b32 v82, 0
    v_mov_b32 v83, 0
    v_mov_b32 v84, 0
    v_mov_b32 v85, 0
    v_mov_b32 v86, 0
    v_mov_b32 v87, 0
    v_mov_b32 v88, 0
    v_mov_b32 v89, 0
    v_mov_b32 v90, 0
    v_mov_b32 v91, 0
    v_mov_b32 v92, 0
    v_mov_b32 v93, 0
    v_mov_b32 v94, 0
    v_mov_b32 v95, 0
    v_mov_b32 v96, 0
    v_mov_b32 v97, 0
    v_mov_b32 v98, 0
    v_mov_b32 v99, 0
    v_mov_b32 v100, 0
    v_mov_b32 v101, 0
    v_mov_b32 v102, 0
    v_mov_b32 v103, 0
    v_mov_b32 v104, 0
    v_mov_b32 v105, 0
    v_mov_b32 v106, 0
    v_mov_b32 v107, 0
    v_mov_b32 v108, 0
    v_mov_b32 v109, 0
    v_mov_b32 v110, 0
    v_mov_b32 v111, 0
    v_mov_b32 v120, 0
    v_mov_b32 v121, 0
    v_mov_b32 v122, 0
    v_mov_b32 v123, 0
    s_mov_b32 s32, 0
    s_mov_b32 s33, 40960
    s_mov_b32 s35, 40960
    s_mov_b32 s45, 0xffff0000
    v_lshlrev_b32 v140, 3, v13
    s_mul_i32 s44, s18, 22528
    s_lshl_b32 s46, s17, 11
    s_lshl_b32 s47, s21, 10
    s_add_u32 s44, s44, s46
    s_add_u32 s44, s44, s47
    s_add_u32 s44, s44, 9437184
    s_lshl_b32 s46, s18, 4
    s_add_u32 s46, s46, s17
    v_mov_b32 v141, 1
    v_mov_b32 v142, 0
    s_waitcnt lgkmcnt(0)
    s_mov_b32 s12, s50
    s_and_b32 s13, s51, 0xffff
    s_mov_b32 s14, 33554432
    s_mov_b32 s15, 0x00020000
    s_mov_b32 s8, s48
    s_and_b32 s9, s49, 0xffff
    s_mov_b32 s10, 256
    s_mov_b32 s11, 0x00020000
    s_mov_b32 s4, s4
    s_and_b32 s5, s5, 0xffff
    s_mov_b32 s6, 8388608
    s_mov_b32 s7, 0x00020000
    s_cmp_eq_u32 s19, 1
    s_cbranch_scc0 K1_nozero
    s_mov_b64 exec, 0xffffffff
    buffer_store_dwordx2 v[64:65], v140, s[12:15], s44 offen sc1
    s_mov_b64 exec, -1
K1_nozero:
    s_lshl_b32 s53, s17, 7
    s_lshl_b32 s47, s18, 2
    s_add_u32 s53, s53, s47
    s_add_u32 s53, s53, 25165824
    s_add_u32 s54, s53, 16384
    s_cmp_eq_u32 s16, 0
    s_cbranch_scc0 K1_nozero2
    s_mov_b64 exec, 0xff
    v_lshlrev_b32 v5, 11, v2
    buffer_store_dword v64, v5, s[12:15], s53 offen sc1
    buffer_store_dword v64, v5, s[12:15], s54 offen sc1
    s_and_b32 s47, s2, 7
    s_lshl_b32 s47, s47, 2
    s_bfe_u32 s34, s2, 0x20003
    s_or_b32 s47, s47, s34
    s_lshr_b32 s34, s2, 5
    s_mov_b64 exec, 31
    s_lshl_b32 s36, s34, 10
    s_lshl_b32 s37, s47, 2
    s_add_u32 s36, s36, s37
    v_lshl_add_u32 v5, v2, 8, s36
    s_lshl_b32 s36, s47, 8
    s_lshl_b32 s37, s34, 2
    s_add_u32 s36, s36, s37
    s_add_u32 s36, s36, 128
    v_writelane_b32 v5, s36, 4
    s_mov_b32 s36, 25198592
    buffer_store_dword v64, v5, s[12:15], s36 offen sc1
    s_mov_b64 exec, -1
K1_nozero2:
    s_barrier
    ds_read_b128 v[16:19], v112
    ds_read_b64_tr_b16 v[24:25], v116 offset:0
    ds_read_b64_tr_b16 v[26:27], v116 offset:512
    ds_read_b64_tr_b16 v[28:29], v116 offset:8192
    ds_read_b64_tr_b16 v[30:31], v116 offset:8704
    ds_read_b64_tr_b16 v[32:33], v116 offset:16384
    ds_read_b64_tr_b16 v[34:35], v116 offset:16896
    s_cmp_eq_u32 s19, 1
    s_cbranch_scc1 K1_loopZ
K1_loopQ:
    s_waitcnt lgkmcnt(0)
    v_mfma_f32_32x32x16_bf16 v[64:79], v[24:27], v[16:19], v[64:79]
    ds_read_b128 v[20:23], v113
    ds_read_b64_tr_b16 v[36:37], v117 offset:0
    ds_read_b64_tr_b16 v[38:39], v117 offset:512
    ds_read_b64_tr_b16 v[40:41], v117 offset:8192
    v_mfma_f32_32x32x16_bf16 v[80:95], v[16:19], v[28:31], v[80:95]
    ds_read_b64_tr_b16 v[42:43], v117 offset:8704
    ds_read_b64_tr_b16 v[44:45], v117 offset:16384
    ds_read_b64_tr_b16 v[46:47], v117 offset:16896
    v_lshlrev_b32 v124, 16, v16
    v_and_b32 v125, s45, v16
    v_add_f32 v120, v120, v124
    v_add_f32 v121, v121, v125
    v_fmac_f32 v122, v124, v124
    v_fmac_f32 v123, v125, v125
    v_lshlrev_b32 v126, 16, v17
    v_and_b32 v127, s45, v17
    v_mfma_f32_32x32x16_bf16 v[96:111], v[16:19], v[32:35], v[96:111]
    v_add_f32 v120, v120, v126
    v_add_f32 v121, v121, v127
    v_fmac_f32 v122, v126, v126
    v_fmac_f32 v123, v127, v127
    v_lshlrev_b32 v124, 16, v18
    v_and_b32 v125, s45, v18
    v_add_f32 v120, v120, v124
    v_add_f32 v121, v121, v125
    v_fmac_f32 v122, v124, v124
    v_fmac_f32 v123, v125, v125
    v_lshlrev_b32 v126, 16, v19
    v_and_b32 v127, s45, v19
    v_add_f32 v120, v120, v126
    v_add_f32 v121, v121, v127
    v_fmac_f32 v122, v126, v126
    v_fmac_f32 v123, v127, v127
    v_mfma_f32_16x16x32_bf16 v[52:55], v[48:51], v[24:27], v[52:55]
    v_mfma_f32_16x16x32_bf16 v[56:59], v[48:51], v[28:31], v[56:59]
    v_mfma_f32_16x16x32_bf16 v[60:63], v[48:51], v[32:35], v[60:63]
    s_waitcnt lgkmcnt(0)
    v_mfma_f32_32x32x16_bf16 v[64:79], v[36:39], v[20:23], v[64:79]
    ds_read_b128 v[16:19], v114
    ds_read_b64_tr_b16 v[24:25], v118 offset:0
    ds_read_b64_tr_b16 v[26:27], v118 offset:512
    ds_read_b64_tr_b16 v[28:29], v118 offset:8192
    v_mfma_f32_32x32x16_bf16 v[80:95], v[20:23], v[40:43], v[80:95]
    ds_read_b64_tr_b16 v[30:31], v118 offset:8704
    ds_read_b64_tr_b16 v[32:33], v118 offset:16384
    ds_read_b64_tr_b16 v[34:35], v118 offset:16896
    s_add_u32 s33, s33, 40960
    s_cmp_ge_u32 s33, 163840
    v_mfma_f32_32x32x16_bf16 v[96:111], v[20:23], v[44:47], v[96:111]
    s_cselect_b32 s34, 4294844416, s35
    s_cselect_b32 s33, 0, s33
    v_add_u32 v112, s34, v112
    v_add_u32 v116, s34, v116
    v_add_u32 v113, s34, v113
    v_add_u32 v117, s34, v117
    s_waitcnt lgkmcnt(0)
    v_mfma_f32_32x32x16_bf16 v[64:79], v[24:27], v[16:19], v[64:79]
    ds_read_b128 v[20:23], v115
    ds_read_b64_tr_b16 v[36:37], v119 offset:0
    ds_read_b64_tr_b16 v[38:39], v119 offset:512
    ds_read_b64_tr_b16 v[40:41], v119 offset:8192
    v_mfma_f32_32x32x16_bf16 v[80:95], v[16:19], v[28:31], v[80:95]
    ds_read_b64_tr_b16 v[42:43], v119 offset:8704
    ds_read_b64_tr_b16 v[44:45], v119 offset:16384
    ds_read_b64_tr_b16 v[46:47], v119 offset:16896
    v_lshlrev_b32 v124, 16, v16
    v_and_b32 v125, s45, v16
    v_add_f32 v120, v120, v124
    v_add_f32 v121, v121, v125
    v_fmac_f32 v122, v124, v124
    v_fmac_f32 v123, v125, v125
    v_lshlrev_b32 v126, 16, v17
    v_and_b32 v127, s45, v17
    v_mfma_f32_32x32x16_bf16 v[96:111], v[16:19], v[32:35], v[96:111]
    v_add_f32 v120, v120, v126
    v_add_f32 v121, v121, v127
    v_fmac_f32 v122, v126, v126
    v_fmac_f32 v123, v127, v127
    v_lshlrev_b32 v124, 16, v18
    v_and_b32 v125, s45, v18
    v_add_f32 v120, v120, v124
    v_add_f32 v121, v121, v125
    v_fmac_f32 v122, v124, v124
    v_fmac_f32 v123, v125, v125
    v_lshlrev_b32 v126, 16, v19
    v_and_b32 v127, s45, v19
    v_add_f32 v120, v120, v126
    v_add_f32 v121, v121, v127
    v_fmac_f32 v122, v126, v126
    v_fmac_f32 v123, v127, v127
    s_waitcnt lgkmcnt(0)
    v_mfma_f32_32x32x16_bf16 v[64:79], v[36:39], v[20:23], v[64:79]
    s_cmp_eq_u32 s32, 0
    s_cbranch_scc1 K1_firstQ
    s_barrier
K1_firstbackQ:
    ds_read_b128 v[16:19], v112
    ds_read_b64_tr_b16 v[24:25], v116 offset:0
    ds_read_b64_tr_b16 v[26:27], v116 offset:512
    ds_read_b64_tr_b16 v[28:29], v116 offset:8192
    v_mfma_f32_32x32x16_bf16 v[80:95], v[20:23], v[40:43], v[80:95]
    ds_read_b64_tr_b16 v[30:31], v116 offset:8704
    ds_read_b64_tr_b16 v[32:33], v116 offset:16384
    ds_read_b64_tr_b16 v[34:35], v116 offset:16896
    v_add_u32 v114, s34, v114
    v_mfma_f32_32x32x16_bf16 v[96:111], v[20:23], v[44:47], v[96:111]
    v_add_u32 v118, s34, v118
    v_add_u32 v115, s34, v115
    v_add_u32 v119, s34, v119
    s_add_u32 s32, s32, 1
    s_cmp_lt_u32 s32, 8
    s_cbranch_scc1 K1_loopQ
    s_waitcnt lgkmcnt(0)
    s_setprio 2
    v_and_b32 v5, 15, v2
    v_lshl_add_u32 v5, v4, 4, v5
    s_lshl_b32 s23, s21, 9
    s_add_u32 s23, s23, 133120
    s_lshl_b32 s22, s20, 2
    s_add_u32 s22, s22, s23
    v_lshl_add_u32 v5, v5, 4, s22
    ds_write_b32 v5, v52 offset:0
    ds_write_b32 v5, v56 offset:1024
    ds_write_b32 v5, v60 offset:2048
    v_add_f32 v120, v120, v121
    v_add_f32 v122, v122, v123
    v_mov_b32 v121, v120
    v_mov_b32 v123, v122
    v_lshl_add_u32 v7, v3, 4, s23
    s_lshl_b32 s22, s21, 10
    s_add_u32 s22, s22, 131072
    v_permlane32_swap_b32 v120, v121
    v_permlane32_swap_b32 v122, v123
    v_add_u32 v6, s22, v140
    v_add_f32 v120, v120, v121
    v_add_f32 v121, v122, v123
    ds_write_b64 v6, v[120:121]
    v_xor_b32 v6, 1024, v6
    s_mul_i32 s22, s16, 768
    s_add_u32 s39, s22, 139264
    v_lshl_add_u32 v9, v3, 2, s39
    v_lshl_add_u32 v10, v4, 4, s39
    s_lshl_b32 s22, s18, 2
    s_add_u32 s22, s22, s20
    s_and_b32 s34, s17, 7
    s_lshl_b32 s34, s34, 8
    s_lshl_b32 s35, s21, 7
    s_add_u32 s34, s34, s35
    s_add_u32 s36, s22, s34
    s_cmp_ge_u32 s17, 8
    s_cselect_b32 s38, 11, 10
    s_cselect_b32 s37, 2097152, 0
    s_mov_b32 s40, 0x3eb8aa3b
    s_cmov_b32 s40, 1.0
    s_lshl_b32 s36, s36, s38
    s_add_u32 s36, s36, s37
    s_lshl_b32 s41, 64, s38
    v_lshlrev_b32 v11, 4, v2
    v_add_u32 v15, s41, v11
    s_waitcnt lgkmcnt(0)
    s_barrier
    ds_read_b64 v[122:123], v6
    ds_read_b128 v[52:55], v7 offset:0
    ds_read_b128 v[56:59], v7 offset:1024
    ds_read_b128 v[60:63], v7 offset:2048
    s_waitcnt lgkmcnt(3)
    v_add_f32 v120, v120, v122
    v_add_f32 v121, v121, v123
    v_mul_f32 v132, 0x3b000000, v120
    v_mul_f32 v122, 0x3b000000, v121
    v_fma_f32 v122, -v132, v132, v122
    v_max_f32 v122, 0, v122
    v_cvt_pk_bf16_f32 v122, v122, v122
    v_and_b32 v122, 0xffff0000, v122
    v_add_f32 v122, 0x3727c5ac, v122
    v_cvt_pk_bf16_f32 v122, v122, v122
    v_and_b32 v122, 0xffff0000, v122
    v_sqrt_f32 v122, v122
    s_nop 0
    v_cvt_pk_bf16_f32 v122, v122, v122
    v_and_b32 v122, 0xffff0000, v122
    v_rcp_f32 v134, v122
    v_cvt_pk_bf16_f32 v132, v132, v132
    v_and_b32 v132, 0xffff0000, v132
    s_waitcnt lgkmcnt(0)
    v_add_f32 v52, v52, v53
    v_add_f32 v54, v54, v55
    v_add_f32 v124, v52, v54
    v_add_f32 v56, v56, v57
    v_add_f32 v58, v58, v59
    v_add_f32 v126, v56, v58
    v_add_f32 v60, v60, v61
    v_add_f32 v62, v62, v63
    v_add_f32 v128, v60, v62
    ds_write_b32 v9, v124 offset:0
    ds_read_b128 v[144:147], v10 offset:0
    ds_read_b128 v[148:151], v10 offset:32
    ds_read_b128 v[152:155], v10 offset:64
    ds_read_b128 v[156:159], v10 offset:96
    ds_write_b32 v9, v132 offset:512
    ds_write_b32 v9, v134 offset:640
    ds_read_b128 v[16:19], v10 offset:512
    ds_read_b128 v[32:35], v10 offset:640
    ds_read_b128 v[20:23], v10 offset:544
    ds_read_b128 v[36:39], v10 offset:672
    ds_read_b128 v[24:27], v10 offset:576
    ds_read_b128 v[40:43], v10 offset:704
    ds_read_b128 v[28:31], v10 offset:608
    ds_read_b128 v[44:47], v10 offset:736
    s_sub_u32 s34, s17, 11
    s_lshl_b32 s34, s34, 8
    s_add_u32 s34, s34, s35
    s_add_u32 s42, s22, s34
    s_lshl_b32 s42, s42, 11
    s_add_u32 s42, s42, 2097152
    s_add_u32 s43, s42, 2621440
    v_bfe_u32 v12, v2, 4, 1
    v_lshlrev_b32 v12, 17, v12
    v_and_b32 v14, 15, v2
    v_lshl_add_u32 v14, v4, 4, v14
    v_lshl_add_u32 v12, v14, 4, v12
    s_waitcnt lgkmcnt(10)
    v_mul_f32 v136, s40, v134
    v_pk_fma_f32 v[64:65], v[144:145], v[132:133], v[64:65] op_sel_hi:[1,0,1] neg_lo:[0,1,0] neg_hi:[0,1,0]
    v_pk_fma_f32 v[66:67], v[146:147], v[132:133], v[66:67] op_sel_hi:[1,0,1] neg_lo:[0,1,0] neg_hi:[0,1,0]
    v_pk_fma_f32 v[68:69], v[148:149], v[132:133], v[68:69] op_sel_hi:[1,0,1] neg_lo:[0,1,0] neg_hi:[0,1,0]
    v_pk_fma_f32 v[70:71], v[150:151], v[132:133], v[70:71] op_sel_hi:[1,0,1] neg_lo:[0,1,0] neg_hi:[0,1,0]
    v_pk_fma_f32 v[72:73], v[152:153], v[132:133], v[72:73] op_sel_hi:[1,0,1] neg_lo:[0,1,0] neg_hi:[0,1,0]
    v_pk_fma_f32 v[74:75], v[154:155], v[132:133], v[74:75] op_sel_hi:[1,0,1] neg_lo:[0,1,0] neg_hi:[0,1,0]
    v_pk_fma_f32 v[76:77], v[156:157], v[132:133], v[76:77] op_sel_hi:[1,0,1] neg_lo:[0,1,0] neg_hi:[0,1,0]
    v_pk_fma_f32 v[78:79], v[158:159], v[132:133], v[78:79] op_sel_hi:[1,0,1] neg_lo:[0,1,0] neg_hi:[0,1,0]
    v_pk_mul_f32 v[64:65], v[64:65], v[136:137] op_sel_hi:[1,0]
    v_pk_mul_f32 v[66:67], v[66:67], v[136:137] op_sel_hi:[1,0]
    v_pk_mul_f32 v[68:69], v[68:69], v[136:137] op_sel_hi:[1,0]
    v_pk_mul_f32 v[70:71], v[70:71], v[136:137] op_sel_hi:[1,0]
    v_pk_mul_f32 v[72:73], v[72:73], v[136:137] op_sel_hi:[1,0]
    v_pk_mul_f32 v[74:75], v[74:75], v[136:137] op_sel_hi:[1,0]
    v_pk_mul_f32 v[76:77], v[76:77], v[136:137] op_sel_hi:[1,0]
    v_pk_mul_f32 v[78:79], v[78:79], v[136:137] op_sel_hi:[1,0]
    v_cvt_pk_bf16_f32 v160, v64, v65
    v_cvt_pk_bf16_f32 v161, v66, v67
    v_cvt_pk_bf16_f32 v162, v68, v69
    v_cvt_pk_bf16_f32 v163, v70, v71
    buffer_store_dwordx4 v[160:163], v11, s[12:15], s36 offen sc1
    v_cvt_pk_bf16_f32 v164, v72, v73
    v_cvt_pk_bf16_f32 v165, v74, v75
    v_cvt_pk_bf16_f32 v166, v76, v77
    v_cvt_pk_bf16_f32 v167, v78, v79
    buffer_store_dwordx4 v[164:167], v15, s[12:15], s36 offen sc1
    s_waitcnt lgkmcnt(0)
    v_pk_fma_f32 v[80:81], v[16:17], v[126:127], v[80:81] op_sel_hi:[1,0,1] neg_lo:[0,1,0] neg_hi:[0,1,0]
    v_pk_fma_f32 v[82:83], v[18:19], v[126:127], v[82:83] op_sel_hi:[1,0,1] neg_lo:[0,1,0] neg_hi:[0,1,0]
    v_pk_fma_f32 v[84:85], v[20:21], v[126:127], v[84:85] op_sel_hi:[1,0,1] neg_lo:[0,1,0] neg_hi:[0,1,0]
    v_pk_fma_f32 v[86:87], v[22:23], v[126:127], v[86:87] op_sel_hi:[1,0,1] neg_lo:[0,1,0] neg_hi:[0,1,0]
    v_pk_fma_f32 v[88:89], v[24:25], v[126:127], v[88:89] op_sel_hi:[1,0,1] neg_lo:[0,1,0] neg_hi:[0,1,0]
    v_pk_fma_f32 v[90:91], v[26:27], v[126:127], v[90:91] op_sel_hi:[1,0,1] neg_lo:[0,1,0] neg_hi:[0,1,0]
    v_pk_fma_f32 v[92:93], v[28:29], v[126:127], v[92:93] op_sel_hi:[1,0,1] neg_lo:[0,1,0] neg_hi:[0,1,0]
    v_pk_fma_f32 v[94:95], v[30:31], v[126:127], v[94:95] op_sel_hi:[1,0,1] neg_lo:[0,1,0] neg_hi:[0,1,0]
    v_pk_mul_f32 v[80:81], v[80:81], v[32:33]
    v_pk_mul_f32 v[82:83], v[82:83], v[34:35]
    v_pk_mul_f32 v[84:85], v[84:85], v[36:37]
    v_pk_mul_f32 v[86:87], v[86:87], v[38:39]
    v_pk_mul_f32 v[88:89], v[88:89], v[40:41]
    v_pk_mul_f32 v[90:91], v[90:91], v[42:43]
    v_pk_mul_f32 v[92:93], v[92:93], v[44:45]
    v_pk_mul_f32 v[94:95], v[94:95], v[46:47]
    v_cvt_pk_bf16_f32 v48, v80, v81
    v_cvt_pk_bf16_f32 v49, v82, v83
    v_cvt_pk_bf16_f32 v50, v84, v85
    v_cvt_pk_bf16_f32 v51, v86, v87
    buffer_store_dwordx4 v[48:51], v12, s[12:15], s42 offen offset:1024 sc1
    v_cvt_pk_bf16_f32 v52, v88, v89
    v_cvt_pk_bf16_f32 v53, v90, v91
    v_cvt_pk_bf16_f32 v54, v92, v93
    v_cvt_pk_bf16_f32 v55, v94, v95
    buffer_store_dwordx4 v[52:55], v12, s[12:15], s42 offen offset:1536 sc1
    s_cmp_ge_u32 s17, 14
    s_cbranch_scc1 K1_qdone
    v_pk_fma_f32 v[96:97], v[16:17], v[128:129], v[96:97] op_sel_hi:[1,0,1] neg_lo:[0,1,0] neg_hi:[0,1,0]
    v_pk_fma_f32 v[98:99], v[18:19], v[128:129], v[98:99] op_sel_hi:[1,0,1] neg_lo:[0,1,0] neg_hi:[0,1,0]
    v_pk_fma_f32 v[100:101], v[20:21], v[128:129], v[100:101] op_sel_hi:[1,0,1] neg_lo:[0,1,0] neg_hi:[0,1,0]
    v_pk_fma_f32 v[102:103], v[22:23], v[128:129], v[102:103] op_sel_hi:[1,0,1] neg_lo:[0,1,0] neg_hi:[0,1,0]
    v_pk_fma_f32 v[104:105], v[24:25], v[128:129], v[104:105] op_sel_hi:[1,0,1] neg_lo:[0,1,0] neg_hi:[0,1,0]
    v_pk_fma_f32 v[106:107], v[26:27], v[128:129], v[106:107] op_sel_hi:[1,0,1] neg_lo:[0,1,0] neg_hi:[0,1,0]
    v_pk_fma_f32 v[108:109], v[28:29], v[128:129], v[108:109] op_sel_hi:[1,0,1] neg_lo:[0,1,0] neg_hi:[0,1,0]
    v_pk_fma_f32 v[110:111], v[30:31], v[128:129], v[110:111] op_sel_hi:[1,0,1] neg_lo:[0,1,0] neg_hi:[0,1,0]
    v_pk_mul_f32 v[96:97], v[96:97], v[32:33]
    v_pk_mul_f32 v[98:99], v[98:99], v[34:35]
    v_pk_mul_f32 v[100:101], v[100:101], v[36:37]
    v_pk_mul_f32 v[102:103], v[102:103], v[38:39]
    v_pk_mul_f32 v[104:105], v[104:105], v[40:41]
    v_pk_mul_f32 v[106:107], v[106:107], v[42:43]
    v_pk_mul_f32 v[108:109], v[108:109], v[44:45]
    v_pk_mul_f32 v[110:111], v[110:111], v[46:47]
    v_cvt_pk_bf16_f32 v56, v96, v97
    v_cvt_pk_bf16_f32 v57, v98, v99
    v_cvt_pk_bf16_f32 v58, v100, v101
    v_cvt_pk_bf16_f32 v59, v102, v103
    buffer_store_dwordx4 v[56:59], v12, s[12:15], s43 offen offset:1024 sc1
    v_cvt_pk_bf16_f32 v60, v104, v105
    v_cvt_pk_bf16_f32 v61, v106, v107
    v_cvt_pk_bf16_f32 v62, v108, v109
    v_cvt_pk_bf16_f32 v63, v110, v111
    buffer_store_dwordx4 v[60:63], v12, s[12:15], s43 offen offset:1536 sc1
K1_qdone:
    s_waitcnt vmcnt(0)
    s_mov_b64 exec, 1
    v_mov_b32 v48, 162932
    v_mov_b32 v49, 1
    ds_add_rtn_u32 v48, v48, v49
    v_mov_b32 v50, 0
    s_waitcnt lgkmcnt(0)
    v_cmp_eq_u32 vcc, 7, v48
    s_nop 0
    s_cbranch_vccz K1_aq
    s_mov_b64 exec, 0xff
    v_lshlrev_b32 v50, 11, v2
    v_mov_b32 v49, 1
    buffer_store_dword v49, v50, s[12:15], s53 offen sc1
K1_aq:
    s_mov_b64 exec, -1
    s_branch M_attn
K1_pfQ:
    s_mov_b64 exec, 0xffffffff
    buffer_load_dword v139, v143, s[4:7], s58 offen
    s_mov_b64 exec, -1
    s_endpgm
K1_pfZ:
    s_mov_b64 exec, 0xffffffff
    buffer_load_dword v139, v143, s[4:7], s58 offen
    s_mov_b64 exec, -1
    s_endpgm
K1_firstQ:
    s_waitcnt vmcnt(0)
    s_barrier
    s_cmp_eq_u32 s16, 0
    s_cbranch_scc0 K1_firstbackQ
    s_mov_b64 exec, 1
    buffer_store_byte v141, v142, s[8:11], s46 offen sc1
    s_mov_b64 exec, -1
    s_branch K1_firstbackQ
K1_firstZ:
    s_waitcnt vmcnt(0)
    s_barrier
    s_cmp_eq_u32 s16, 0
    s_cbranch_scc0 K1_firstbackZ
    s_mov_b64 exec, 1
    buffer_store_byte v141, v142, s[8:11], s46 offen sc1
    s_mov_b64 exec, -1
    s_branch K1_firstbackZ
K1_loopZ:
    s_waitcnt lgkmcnt(0)
    v_mfma_f32_32x32x16_bf16 v[64:79], v[24:27], v[16:19], v[64:79]
    ds_read_b128 v[20:23], v113
    ds_read_b64_tr_b16 v[36:37], v117 offset:0
    ds_read_b64_tr_b16 v[38:39], v117 offset:512
    ds_read_b64_tr_b16 v[40:41], v117 offset:8192
    v_mfma_f32_32x32x16_bf16 v[80:95], v[28:31], v[16:19], v[80:95]
    ds_read_b64_tr_b16 v[42:43], v117 offset:8704
    ds_read_b64_tr_b16 v[44:45], v117 offset:16384
    ds_read_b64_tr_b16 v[46:47], v117 offset:16896
    v_lshlrev_b32 v124, 16, v16
    v_and_b32 v125, s45, v16
    v_add_f32 v120, v120, v124
    v_add_f32 v121, v121, v125
    v_fmac_f32 v122, v124, v124
    v_fmac_f32 v123, v125, v125
    v_lshlrev_b32 v126, 16, v17
    v_and_b32 v127, s45, v17
    v_mfma_f32_32x32x16_bf16 v[96:111], v[32:35], v[16:19], v[96:111]
    v_add_f32 v120, v120, v126
    v_add_f32 v121, v121, v127
    v_fmac_f32 v122, v126, v126
    v_fmac_f32 v123, v127, v127
    v_lshlrev_b32 v124, 16, v18
    v_and_b32 v125, s45, v18
    v_add_f32 v120, v120, v124
    v_add_f32 v121, v121, v125
    v_fmac_f32 v122, v124, v124
    v_fmac_f32 v123, v125, v125
    v_lshlrev_b32 v126, 16, v19
    v_and_b32 v127, s45, v19
    v_add_f32 v120, v120, v126
    v_add_f32 v121, v121, v127
    v_fmac_f32 v122, v126, v126
    v_fmac_f32 v123, v127, v127
    v_mfma_f32_16x16x32_bf16 v[52:55], v[48:51], v[24:27], v[52:55]
    v_mfma_f32_16x16x32_bf16 v[56:59], v[48:51], v[28:31], v[56:59]
    v_mfma_f32_16x16x32_bf16 v[60:63], v[48:51], v[32:35], v[60:63]
    s_waitcnt lgkmcnt(0)
    v_mfma_f32_32x32x16_bf16 v[64:79], v[36:39], v[20:23], v[64:79]
    ds_read_b128 v[16:19], v114
    ds_read_b64_tr_b16 v[24:25], v118 offset:0
    ds_read_b64_tr_b16 v[26:27], v118 offset:512
    ds_read_b64_tr_b16 v[28:29], v118 offset:8192
    v_mfma_f32_32x32x16_bf16 v[80:95], v[40:43], v[20:23], v[80:95]
    ds_read_b64_tr_b16 v[30:31], v118 offset:8704
    ds_read_b64_tr_b16 v[32:33], v118 offset:16384
    ds_read_b64_tr_b16 v[34:35], v118 offset:16896
    s_add_u32 s33, s33, 40960
    s_cmp_ge_u32 s33, 163840
    v_mfma_f32_32x32x16_bf16 v[96:111], v[44:47], v[20:23], v[96:111]
    s_cselect_b32 s34, 4294844416, s35
    s_cselect_b32 s33, 0, s33
    v_add_u32 v112, s34, v112
    v_add_u32 v116, s34, v116
    v_add_u32 v113, s34, v113
    v_add_u32 v117, s34, v117
    s_waitcnt lgkmcnt(0)
    v_mfma_f32_32x32x16_bf16 v[64:79], v[24:27], v[16:19], v[64:79]
    ds_read_b128 v[20:23], v115
    ds_read_b64_tr_b16 v[36:37], v119 offset:0
    ds_read_b64_tr_b16 v[38:39], v119 offset:512
    ds_read_b64_tr_b16 v[40:41], v119 offset:8192
    v_mfma_f32_32x32x16_bf16 v[80:95], v[28:31], v[16:19], v[80:95]
    ds_read_b64_tr_b16 v[42:43], v119 offset:8704
    ds_read_b64_tr_b16 v[44:45], v119 offset:16384
    ds_read_b64_tr_b16 v[46:47], v119 offset:16896
    v_lshlrev_b32 v124, 16, v16
    v_and_b32 v125, s45, v16
    v_add_f32 v120, v120, v124
    v_add_f32 v121, v121, v125
    v_fmac_f32 v122, v124, v124
    v_fmac_f32 v123, v125, v125
    v_lshlrev_b32 v126, 16, v17
    v_and_b32 v127, s45, v17
    v_mfma_f32_32x32x16_bf16 v[96:111], v[32:35], v[16:19], v[96:111]
    v_add_f32 v120, v120, v126
    v_add_f32 v121, v121, v127
    v_fmac_f32 v122, v126, v126
    v_fmac_f32 v123, v127, v127
    v_lshlrev_b32 v124, 16, v18
    v_and_b32 v125, s45, v18
    v_add_f32 v120, v120, v124
    v_add_f32 v121, v121, v125
    v_fmac_f32 v122, v124, v124
    v_fmac_f32 v123, v125, v125
    v_lshlrev_b32 v126, 16, v19
    v_and_b32 v127, s45, v19
    v_add_f32 v120, v120, v126
    v_add_f32 v121, v121, v127
    v_fmac_f32 v122, v126, v126
    v_fmac_f32 v123, v127, v127
    s_waitcnt lgkmcnt(0)
    v_mfma_f32_32x32x16_bf16 v[64:79], v[36:39], v[20:23], v[64:79]
    s_cmp_eq_u32 s32, 0
    s_cbranch_scc1 K1_firstZ
    s_barrier
K1_firstbackZ:
    ds_read_b128 v[16:19], v112
    ds_read_b64_tr_b16 v[24:25], v116 offset:0
    ds_read_b64_tr_b16 v[26:27], v116 offset:512
    ds_read_b64_tr_b16 v[28:29], v116 offset:8192
    v_mfma_f32_32x32x16_bf16 v[80:95], v[40:43], v[20:23], v[80:95]
    ds_read_b64_tr_b16 v[30:31], v116 offset:8704
    ds_read_b64_tr_b16 v[32:33], v116 offset:16384
    ds_read_b64_tr_b16 v[34:35], v116 offset:16896
    v_add_u32 v114, s34, v114
    v_mfma_f32_32x32x16_bf16 v[96:111], v[44:47], v[20:23], v[96:111]
    v_add_u32 v118, s34, v118
    v_add_u32 v115, s34, v115
    v_add_u32 v119, s34, v119
    s_add_u32 s32, s32, 1
    s_cmp_lt_u32 s32, 8
    s_cbranch_scc1 K1_loopZ
    s_waitcnt lgkmcnt(0)
    s_setprio 2
    v_and_b32 v5, 15, v2
    v_lshl_add_u32 v5, v4, 4, v5
    s_lshl_b32 s23, s21, 9
    s_add_u32 s23, s23, 133120
    s_lshl_b32 s22, s20, 2
    s_add_u32 s22, s22, s23
    v_lshl_add_u32 v5, v5, 4, s22
    ds_write_b32 v5, v52 offset:0
    ds_write_b32 v5, v56 offset:1024
    ds_write_b32 v5, v60 offset:2048
    v_add_f32 v120, v120, v121
    v_add_f32 v122, v122, v123
    v_mov_b32 v121, v120
    v_mov_b32 v123, v122
    v_lshl_add_u32 v7, v3, 4, s23
    s_lshl_b32 s22, s21, 10
    s_add_u32 s22, s22, 131072
    v_permlane32_swap_b32 v120, v121
    v_permlane32_swap_b32 v122, v123
    v_add_u32 v6, s22, v140
    v_add_f32 v120, v120, v121
    v_add_f32 v121, v122, v123
    ds_write_b64 v6, v[120:121]
    v_xor_b32 v6, 1024, v6
    s_mul_i32 s22, s16, 768
    s_add_u32 s39, s22, 139264
    v_lshl_add_u32 v9, v3, 2, s39
    v_lshl_add_u32 v10, v4, 4, s39
    s_lshl_b32 s22, s18, 2
    s_add_u32 s22, s22, s20
    s_and_b32 s34, s17, 7
    s_lshl_b32 s34, s34, 8
    s_lshl_b32 s35, s21, 7
    s_add_u32 s34, s34, s35
    s_add_u32 s36, s22, s34
    s_cmp_ge_u32 s17, 8
    s_cselect_b32 s38, 11, 10
    s_cselect_b32 s37, 2097152, 0
    s_mov_b32 s40, 0x3eb8aa3b
    s_cmov_b32 s40, 1.0
    s_lshl_b32 s36, s36, s38
    s_add_u32 s36, s36, s37
    s_lshl_b32 s41, 64, s38
    v_lshlrev_b32 v11, 4, v2
    v_add_u32 v15, s41, v11
    s_waitcnt lgkmcnt(0)
    s_barrier
    ds_read_b64 v[122:123], v6
    ds_read_b128 v[52:55], v7 offset:0
    ds_read_b128 v[56:59], v7 offset:1024
    ds_read_b128 v[60:63], v7 offset:2048
    s_waitcnt lgkmcnt(3)
    v_add_f32 v120, v120, v122
    v_add_f32 v121, v121, v123
    v_mul_f32 v132, 0x3b000000, v120
    v_mul_f32 v122, 0x3b000000, v121
    v_fma_f32 v122, -v132, v132, v122
    v_max_f32 v122, 0, v122
    v_cvt_pk_bf16_f32 v122, v122, v122
    v_and_b32 v122, 0xffff0000, v122
    v_add_f32 v122, 0x3727c5ac, v122
    v_cvt_pk_bf16_f32 v122, v122, v122
    v_and_b32 v122, 0xffff0000, v122
    v_sqrt_f32 v122, v122
    s_nop 0
    v_cvt_pk_bf16_f32 v122, v122, v122
    v_and_b32 v122, 0xffff0000, v122
    v_rcp_f32 v134, v122
    v_cvt_pk_bf16_f32 v132, v132, v132
    v_and_b32 v132, 0xffff0000, v132
    s_waitcnt lgkmcnt(0)
    v_add_f32 v52, v52, v53
    v_add_f32 v54, v54, v55
    v_add_f32 v124, v52, v54
    v_add_f32 v56, v56, v57
    v_add_f32 v58, v58, v59
    v_add_f32 v126, v56, v58
    v_add_f32 v60, v60, v61
    v_add_f32 v62, v62, v63
    v_add_f32 v128, v60, v62
    ds_write_b32 v9, v124 offset:0
    ds_read_b128 v[144:147], v10 offset:0
    ds_read_b128 v[148:151], v10 offset:32
    ds_read_b128 v[152:155], v10 offset:64
    ds_read_b128 v[156:159], v10 offset:96
    ds_write_b32 v9, v126 offset:128
    ds_read_b128 v[16:19], v10 offset:128
    ds_read_b128 v[20:23], v10 offset:160
    ds_read_b128 v[24:27], v10 offset:192
    ds_read_b128 v[28:31], v10 offset:224
    ds_write_b32 v9, v128 offset:256
    ds_read_b128 v[32:35], v10 offset:256
    ds_read_b128 v[36:39], v10 offset:288
    ds_read_b128 v[40:43], v10 offset:320
    ds_read_b128 v[44:47], v10 offset:352
    v_mul_f32 v114, 0xc0135761, v134
    v_mul_f32 v112, v134, v134
    v_mul_f32 v112, v112, v114
    v_mul_f32 v112, 0x3d372713, v112
    v_mov_b32 v116, v122
    v_mov_b32 v118, 0
    v_mov_b32 v119, 0
    v_mov_b32 v120, 0
    v_mov_b32 v121, 0
    s_mul_i32 s42, s22, 43
    s_lshl_b32 s34, s17, 2
    s_lshl_b32 s35, s21, 1
    s_add_u32 s34, s34, s35
    s_add_u32 s42, s42, s34
    s_lshl_b32 s42, s42, 10
    s_add_u32 s42, s42, 6291456
    s_waitcnt lgkmcnt(10)
    v_mul_f32 v136, s40, v134
    v_pk_fma_f32 v[64:65], v[144:145], v[132:133], v[64:65] op_sel_hi:[1,0,1] neg_lo:[0,1,0] neg_hi:[0,1,0]
    v_pk_fma_f32 v[66:67], v[146:147], v[132:133], v[66:67] op_sel_hi:[1,0,1] neg_lo:[0,1,0] neg_hi:[0,1,0]
    v_pk_fma_f32 v[68:69], v[148:149], v[132:133], v[68:69] op_sel_hi:[1,0,1] neg_lo:[0,1,0] neg_hi:[0,1,0]
    v_pk_fma_f32 v[70:71], v[150:151], v[132:133], v[70:71] op_sel_hi:[1,0,1] neg_lo:[0,1,0] neg_hi:[0,1,0]
    v_pk_fma_f32 v[72:73], v[152:153], v[132:133], v[72:73] op_sel_hi:[1,0,1] neg_lo:[0,1,0] neg_hi:[0,1,0]
    v_pk_fma_f32 v[74:75], v[154:155], v[132:133], v[74:75] op_sel_hi:[1,0,1] neg_lo:[0,1,0] neg_hi:[0,1,0]
    v_pk_fma_f32 v[76:77], v[156:157], v[132:133], v[76:77] op_sel_hi:[1,0,1] neg_lo:[0,1,0] neg_hi:[0,1,0]
    v_pk_fma_f32 v[78:79], v[158:159], v[132:133], v[78:79] op_sel_hi:[1,0,1] neg_lo:[0,1,0] neg_hi:[0,1,0]
    v_pk_mul_f32 v[64:65], v[64:65], v[136:137] op_sel_hi:[1,0]
    v_pk_mul_f32 v[66:67], v[66:67], v[136:137] op_sel_hi:[1,0]
    v_pk_mul_f32 v[68:69], v[68:69], v[136:137] op_sel_hi:[1,0]
    v_pk_mul_f32 v[70:71], v[70:71], v[136:137] op_sel_hi:[1,0]
    v_pk_mul_f32 v[72:73], v[72:73], v[136:137] op_sel_hi:[1,0]
    v_pk_mul_f32 v[74:75], v[74:75], v[136:137] op_sel_hi:[1,0]
    v_pk_mul_f32 v[76:77], v[76:77], v[136:137] op_sel_hi:[1,0]
    v_pk_mul_f32 v[78:79], v[78:79], v[136:137] op_sel_hi:[1,0]
    v_cvt_pk_bf16_f32 v160, v64, v65
    v_cvt_pk_bf16_f32 v161, v66, v67
    v_cvt_pk_bf16_f32 v162, v68, v69
    v_cvt_pk_bf16_f32 v163, v70, v71
    buffer_store_dwordx4 v[160:163], v11, s[12:15], s36 offen sc1
    v_cvt_pk_bf16_f32 v164, v72, v73
    v_cvt_pk_bf16_f32 v165, v74, v75
    v_cvt_pk_bf16_f32 v166, v76, v77
    v_cvt_pk_bf16_f32 v167, v78, v79
    buffer_store_dwordx4 v[164:167], v15, s[12:15], s36 offen sc1
    v_mul_u32_u24 v12, 136, v13
    v_lshl_add_u32 v12, v4, 3, v12
    s_lshl_b32 s35, s21, 6
    s_add_u32 s35, s35, 145408
    v_add_u32 v12, s35, v12
    s_waitcnt lgkmcnt(5)
    v_pk_fma_f32 v[80:81], v[16:17], v[132:133], v[80:81] op_sel_hi:[1,0,1] neg_lo:[0,1,0] neg_hi:[0,1,0]
    v_pk_fma_f32 v[82:83], v[18:19], v[132:133], v[82:83] op_sel_hi:[1,0,1] neg_lo:[0,1,0] neg_hi:[0,1,0]
    v_pk_fma_f32 v[84:85], v[20:21], v[132:133], v[84:85] op_sel_hi:[1,0,1] neg_lo:[0,1,0] neg_hi:[0,1,0]
    v_pk_fma_f32 v[86:87], v[22:23], v[132:133], v[86:87] op_sel_hi:[1,0,1] neg_lo:[0,1,0] neg_hi:[0,1,0]
    v_pk_fma_f32 v[88:89], v[24:25], v[132:133], v[88:89] op_sel_hi:[1,0,1] neg_lo:[0,1,0] neg_hi:[0,1,0]
    v_pk_fma_f32 v[90:91], v[26:27], v[132:133], v[90:91] op_sel_hi:[1,0,1] neg_lo:[0,1,0] neg_hi:[0,1,0]
    v_pk_fma_f32 v[92:93], v[28:29], v[132:133], v[92:93] op_sel_hi:[1,0,1] neg_lo:[0,1,0] neg_hi:[0,1,0]
    v_pk_fma_f32 v[94:95], v[30:31], v[132:133], v[94:95] op_sel_hi:[1,0,1] neg_lo:[0,1,0] neg_hi:[0,1,0]
    s_cmp_eq_u32 s34, 0
    s_cbranch_scc1 K1_noblk
    v_pk_mul_f32 v[48:49], v[80:81], v[80:81]
    v_pk_mul_f32 v[50:51], v[82:83], v[82:83]
    v_pk_mul_f32 v[52:53], v[84:85], v[84:85]
    v_pk_mul_f32 v[54:55], v[86:87], v[86:87]
    v_pk_fma_f32 v[48:49], v[48:49], v[112:113], v[114:115] op_sel_hi:[1,0,0]
    v_pk_fma_f32 v[50:51], v[50:51], v[112:113], v[114:115] op_sel_hi:[1,0,0]
    v_pk_fma_f32 v[52:53], v[52:53], v[112:113], v[114:115] op_sel_hi:[1,0,0]
    v_pk_fma_f32 v[54:55], v[54:55], v[112:113], v[114:115] op_sel_hi:[1,0,0]
    v_pk_mul_f32 v[48:49], v[48:49], v[80:81]
    v_pk_mul_f32 v[50:51], v[50:51], v[82:83]
    v_pk_mul_f32 v[52:53], v[52:53], v[84:85]
    v_pk_mul_f32 v[54:55], v[54:55], v[86:87]
    v_exp_f32 v48, v48
    v_exp_f32 v49, v49
    v_exp_f32 v50, v50
    v_exp_f32 v51, v51
    v_exp_f32 v52, v52
    v_exp_f32 v53, v53
    v_exp_f32 v54, v54
    v_exp_f32 v55, v55
    v_pk_fma_f32 v[48:49], v[48:49], v[116:117], v[116:117] op_sel_hi:[1,0,0]
    v_pk_fma_f32 v[50:51], v[50:51], v[116:117], v[116:117] op_sel_hi:[1,0,0]
    v_pk_fma_f32 v[52:53], v[52:53], v[116:117], v[116:117] op_sel_hi:[1,0,0]
    v_pk_fma_f32 v[54:55], v[54:55], v[116:117], v[116:117] op_sel_hi:[1,0,0]
    v_rcp_f32 v48, v48
    v_rcp_f32 v49, v49
    v_rcp_f32 v50, v50
    v_rcp_f32 v51, v51
    v_rcp_f32 v52, v52
    v_rcp_f32 v53, v53
    v_rcp_f32 v54, v54
    v_rcp_f32 v55, v55
    v_pk_mul_f32 v[80:81], v[80:81], v[48:49]
    v_pk_mul_f32 v[82:83], v[82:83], v[50:51]
    v_pk_mul_f32 v[84:85], v[84:85], v[52:53]
    v_pk_mul_f32 v[86:87], v[86:87], v[54:55]
    v_pk_add_f32 v[118:119], v[118:119], v[80:81]
    v_pk_fma_f32 v[120:121], v[80:81], v[80:81], v[120:121]
    v_pk_add_f32 v[118:119], v[118:119], v[82:83]
    v_pk_fma_f32 v[120:121], v[82:83], v[82:83], v[120:121]
    v_pk_add_f32 v[118:119], v[118:119], v[84:85]
    v_pk_fma_f32 v[120:121], v[84:85], v[84:85], v[120:121]
    v_pk_add_f32 v[118:119], v[118:119], v[86:87]
    v_pk_fma_f32 v[120:121], v[86:87], v[86:87], v[120:121]
K1_noblk:
    s_waitcnt vmcnt(0)
    s_mov_b64 exec, 1
    v_mov_b32 v16, 162932
    v_mov_b32 v17, 1
    ds_add_rtn_u32 v16, v16, v17
    v_mov_b32 v18, 0
    s_waitcnt lgkmcnt(0)
    v_cmp_eq_u32 vcc, 7, v16
    s_nop 0
    s_cbranch_vccz K1_am
    s_mov_b64 exec, 0xff
    v_lshlrev_b32 v18, 11, v2
    v_mov_b32 v17, 1
    buffer_store_dword v17, v18, s[12:15], s53 offen sc1
K1_am:
    s_mov_b64 exec, -1
    v_pk_mul_f32 v[48:49], v[88:89], v[88:89]
    v_pk_mul_f32 v[50:51], v[90:91], v[90:91]
    v_pk_mul_f32 v[52:53], v[92:93], v[92:93]
    v_pk_mul_f32 v[54:55], v[94:95], v[94:95]
    v_pk_fma_f32 v[48:49], v[48:49], v[112:113], v[114:115] op_sel_hi:[1,0,0]
    v_pk_fma_f32 v[50:51], v[50:51], v[112:113], v[114:115] op_sel_hi:[1,0,0]
    v_pk_fma_f32 v[52:53], v[52:53], v[112:113], v[114:115] op_sel_hi:[1,0,0]
    v_pk_fma_f32 v[54:55], v[54:55], v[112:113], v[114:115] op_sel_hi:[1,0,0]
    v_pk_mul_f32 v[48:49], v[48:49], v[88:89]
    v_pk_mul_f32 v[50:51], v[50:51], v[90:91]
    v_pk_mul_f32 v[52:53], v[52:53], v[92:93]
    v_pk_mul_f32 v[54:55], v[54:55], v[94:95]
    v_exp_f32 v48, v48
    v_exp_f32 v49, v49
    v_exp_f32 v50, v50
    v_exp_f32 v51, v51
    v_exp_f32 v52, v52
    v_exp_f32 v53, v53
    v_exp_f32 v54, v54
    v_exp_f32 v55, v55
    v_pk_fma_f32 v[48:49], v[48:49], v[116:117], v[116:117] op_sel_hi:[1,0,0]
    v_pk_fma_f32 v[50:51], v[50:51], v[116:117], v[116:117] op_sel_hi:[1,0,0]
    v_pk_fma_f32 v[52:53], v[52:53], v[116:117], v[116:117] op_sel_hi:[1,0,0]
    v_pk_fma_f32 v[54:55], v[54:55], v[116:117], v[116:117] op_sel_hi:[1,0,0]
    v_rcp_f32 v48, v48
    v_rcp_f32 v49, v49
    v_rcp_f32 v50, v50
    v_rcp_f32 v51, v51
    v_rcp_f32 v52, v52
    v_rcp_f32 v53, v53
    v_rcp_f32 v54, v54
    v_rcp_f32 v55, v55
    v_pk_mul_f32 v[88:89], v[88:89], v[48:49]
    v_pk_mul_f32 v[90:91], v[90:91], v[50:51]
    v_pk_mul_f32 v[92:93], v[92:93], v[52:53]
    v_pk_mul_f32 v[94:95], v[94:95], v[54:55]
    v_pk_add_f32 v[118:119], v[118:119], v[88:89]
    v_pk_fma_f32 v[120:121], v[88:89], v[88:89], v[120:121]
    v_pk_add_f32 v[118:119], v[118:119], v[90:91]
    v_pk_fma_f32 v[120:121], v[90:91], v[90:91], v[120:121]
    v_pk_add_f32 v[118:119], v[118:119], v[92:93]
    v_pk_fma_f32 v[120:121], v[92:93], v[92:93], v[120:121]
    v_pk_add_f32 v[118:119], v[118:119], v[94:95]
    v_pk_fma_f32 v[120:121], v[94:95], v[94:95], v[120:121]
    v_add_f32 v118, v118, v119
    v_add_f32 v120, v120, v121
    v_mov_b32 v119, v118
    v_mov_b32 v121, v120
    s_nop 1
    v_permlane32_swap_b32 v118, v119
    v_permlane32_swap_b32 v120, v121
    v_add_f32 v118, v118, v119
    v_add_f32 v119, v120, v121
    v_or_b32 v119, 0x80000000, v119
    s_mov_b64 exec, 0xffffffff
    buffer_store_dwordx2 v[118:119], v140, s[12:15], s44 offen sc1
    s_mov_b64 exec, -1
    v_cvt_pk_bf16_f32 v16, v80, v81
    v_cvt_pk_bf16_f32 v17, v82, v83
    v_cvt_pk_bf16_f32 v18, v84, v85
    v_cvt_pk_bf16_f32 v19, v86, v87
    v_cvt_pk_bf16_f32 v20, v88, v89
    v_cvt_pk_bf16_f32 v21, v90, v91
    v_cvt_pk_bf16_f32 v22, v92, v93
    v_cvt_pk_bf16_f32 v23, v94, v95
    ds_write_b64 v12, v[16:17] offset:0
    ds_write_b64 v12, v[18:19] offset:16
    ds_write_b64 v12, v[20:21] offset:32
    ds_write_b64 v12, v[22:23] offset:48
    s_mov_b64 exec, 1
    v_mov_b32 v24, 162936
    v_mov_b32 v25, 1
    ds_add_u32 v24, v25
    s_mov_b64 exec, -1
    s_waitcnt lgkmcnt(0)
    v_pk_fma_f32 v[96:97], v[32:33], v[132:133], v[96:97] op_sel_hi:[1,0,1] neg_lo:[0,1,0] neg_hi:[0,1,0]
    v_pk_fma_f32 v[98:99], v[34:35], v[132:133], v[98:99] op_sel_hi:[1,0,1] neg_lo:[0,1,0] neg_hi:[0,1,0]
    v_pk_fma_f32 v[100:101], v[36:37], v[132:133], v[100:101] op_sel_hi:[1,0,1] neg_lo:[0,1,0] neg_hi:[0,1,0]
    v_pk_fma_f32 v[102:103], v[38:39], v[132:133], v[102:103] op_sel_hi:[1,0,1] neg_lo:[0,1,0] neg_hi:[0,1,0]
    v_pk_fma_f32 v[104:105], v[40:41], v[132:133], v[104:105] op_sel_hi:[1,0,1] neg_lo:[0,1,0] neg_hi:[0,1,0]
    v_pk_fma_f32 v[106:107], v[42:43], v[132:133], v[106:107] op_sel_hi:[1,0,1] neg_lo:[0,1,0] neg_hi:[0,1,0]
    v_pk_fma_f32 v[108:109], v[44:45], v[132:133], v[108:109] op_sel_hi:[1,0,1] neg_lo:[0,1,0] neg_hi:[0,1,0]
    v_pk_fma_f32 v[110:111], v[46:47], v[132:133], v[110:111] op_sel_hi:[1,0,1] neg_lo:[0,1,0] neg_hi:[0,1,0]
    v_pk_mul_f32 v[48:49], v[96:97], v[96:97]
    v_pk_mul_f32 v[50:51], v[98:99], v[98:99]
    v_pk_mul_f32 v[52:53], v[100:101], v[100:101]
    v_pk_mul_f32 v[54:55], v[102:103], v[102:103]
    v_pk_fma_f32 v[48:49], v[48:49], v[112:113], v[114:115] op_sel_hi:[1,0,0]
    v_pk_fma_f32 v[50:51], v[50:51], v[112:113], v[114:115] op_sel_hi:[1,0,0]
    v_pk_fma_f32 v[52:53], v[52:53], v[112:113], v[114:115] op_sel_hi:[1,0,0]
    v_pk_fma_f32 v[54:55], v[54:55], v[112:113], v[114:115] op_sel_hi:[1,0,0]
    v_pk_mul_f32 v[48:49], v[48:49], v[96:97]
    v_pk_mul_f32 v[50:51], v[50:51], v[98:99]
    v_pk_mul_f32 v[52:53], v[52:53], v[100:101]
    v_pk_mul_f32 v[54:55], v[54:55], v[102:103]
    v_exp_f32 v48, v48
    v_exp_f32 v49, v49
    v_exp_f32 v50, v50
    v_exp_f32 v51, v51
    v_exp_f32 v52, v52
    v_exp_f32 v53, v53
    v_exp_f32 v54, v54
    v_exp_f32 v55, v55
    v_pk_fma_f32 v[48:49], v[48:49], v[116:117], v[116:117] op_sel_hi:[1,0,0]
    v_pk_fma_f32 v[50:51], v[50:51], v[116:117], v[116:117] op_sel_hi:[1,0,0]
    v_pk_fma_f32 v[52:53], v[52:53], v[116:117], v[116:117] op_sel_hi:[1,0,0]
    v_pk_fma_f32 v[54:55], v[54:55], v[116:117], v[116:117] op_sel_hi:[1,0,0]
    v_rcp_f32 v48, v48
    v_rcp_f32 v49, v49
    v_rcp_f32 v50, v50
    v_rcp_f32 v51, v51
    v_rcp_f32 v52, v52
    v_rcp_f32 v53, v53
    v_rcp_f32 v54, v54
    v_rcp_f32 v55, v55
    v_pk_mul_f32 v[96:97], v[96:97], v[48:49]
    v_pk_mul_f32 v[98:99], v[98:99], v[50:51]
    v_pk_mul_f32 v[100:101], v[100:101], v[52:53]
    v_pk_mul_f32 v[102:103], v[102:103], v[54:55]
    v_cvt_pk_bf16_f32 v56, v96, v97
    v_cvt_pk_bf16_f32 v57, v98, v99
    v_cvt_pk_bf16_f32 v58, v100, v101
    v_cvt_pk_bf16_f32 v59, v102, v103
    buffer_store_dwordx4 v[56:59], v11, s[12:15], s42 offen sc1
    s_cmp_eq_u32 s34, 42
    s_cbranch_scc1 K1_noz1
    v_pk_mul_f32 v[48:49], v[104:105], v[104:105]
    v_pk_mul_f32 v[50:51], v[106:107], v[106:107]
    v_pk_mul_f32 v[52:53], v[108:109], v[108:109]
    v_pk_mul_f32 v[54:55], v[110:111], v[110:111]
    v_pk_fma_f32 v[48:49], v[48:49], v[112:113], v[114:115] op_sel_hi:[1,0,0]
    v_pk_fma_f32 v[50:51], v[50:51], v[112:113], v[114:115] op_sel_hi:[1,0,0]
    v_pk_fma_f32 v[52:53], v[52:53], v[112:113], v[114:115] op_sel_hi:[1,0,0]
    v_pk_fma_f32 v[54:55], v[54:55], v[112:113], v[114:115] op_sel_hi:[1,0,0]
    v_pk_mul_f32 v[48:49], v[48:49], v[104:105]
    v_pk_mul_f32 v[50:51], v[50:51], v[106:107]
    v_pk_mul_f32 v[52:53], v[52:53], v[108:109]
    v_pk_mul_f32 v[54:55], v[54:55], v[110:111]
    v_exp_f32 v48, v48
    v_exp_f32 v49, v49
    v_exp_f32 v50, v50
    v_exp_f32 v51, v51
    v_exp_f32 v52, v52
    v_exp_f32 v53, v53
    v_exp_f32 v54, v54
    v_exp_f32 v55, v55
    v_pk_fma_f32 v[48:49], v[48:49], v[116:117], v[116:117] op_sel_hi:[1,0,0]
    v_pk_fma_f32 v[50:51], v[50:51], v[116:117], v[116:117] op_sel_hi:[1,0,0]
    v_pk_fma_f32 v[52:53], v[52:53], v[116:117], v[116:117] op_sel_hi:[1,0,0]
    v_pk_fma_f32 v[54:55], v[54:55], v[116:117], v[116:117] op_sel_hi:[1,0,0]
    v_rcp_f32 v48, v48
    v_rcp_f32 v49, v49
    v_rcp_f32 v50, v50
    v_rcp_f32 v51, v51
    v_rcp_f32 v52, v52
    v_rcp_f32 v53, v53
    v_rcp_f32 v54, v54
    v_rcp_f32 v55, v55
    v_pk_mul_f32 v[104:105], v[104:105], v[48:49]
    v_pk_mul_f32 v[106:107], v[106:107], v[50:51]
    v_pk_mul_f32 v[108:109], v[108:109], v[52:53]
    v_pk_mul_f32 v[110:111], v[110:111], v[54:55]
    v_cvt_pk_bf16_f32 v60, v104, v105
    v_cvt_pk_bf16_f32 v61, v106, v107
    v_cvt_pk_bf16_f32 v62, v108, v109
    v_cvt_pk_bf16_f32 v63, v110, v111
    buffer_store_dwordx4 v[60:63], v11, s[12:15], s42 offen offset:1024 sc1
K1_noz1:
M_attn:
    s_mov_b32 s55, s19
    s_and_b32 s17, s2, 7
    s_lshl_b32 s17, s17, 2
    s_bfe_u32 s18, s2, 0x20003
    s_or_b32 s17, s17, s18
    s_lshr_b32 s18, s2, 5
    s_and_b32 s19, s16, 3
    s_lshr_b32 s33, s16, 2
    v_lshlrev_b32 v152, 4, v2
    s_lshl_b32 s23, s19, 11
    v_add_u32 v146, s23, v152
    s_lshl_b32 s24, s17, 17
    s_add_u32 s24, s24, 2097152
    s_lshl_b32 s20, s33, 16
    s_add_u32 s20, s20, s24
    s_lshl_b32 s21, s18, 3
    s_lshl_b32 s22, s19, 1
    s_add_u32 s21, s21, s22
    s_lshl_b32 s22, s17, 6
    s_add_u32 s22, s22, s21
    s_lshl_b32 s22, s22, 10
    s_lshl_b32 s34, s33, 15
    s_add_u32 s23, s23, s34
    v_lshlrev_b32 v150, 2, v2
    v_add_u32 v150, 162816, v150
    v_and_b32 v147, 7, v2
    v_lshlrev_b32 v147, 2, v147
    s_lshl_b32 s36, s33, 5
    s_add_u32 s36, s36, 162816
    v_add_u32 v147, s36, v147
    v_add_u32 v148, 256, v150
    s_lshl_b32 s37, s19, 2
    s_add_u32 s37, s37, s36
    v_writelane_b32 v148, s37, 0
    v_add_u32 v144, s34, v152
    v_and_b32 v145, 15, v2
    v_lshlrev_b32 v145, 4, v145
    v_lshrrev_b32 v150, 5, v2
    v_lshl_add_u32 v145, v150, 8, v145
    s_add_u32 s38, s34, 1024
    v_add_u32 v145, s38, v145
    s_mov_b32 s26, 0x0000ffff
    s_mov_b32 s27, 0x0000ffff
    s_mov_b32 s40, 0x0f0f0f0f
    s_mov_b32 s41, 0x0f0f0f0f
    s_mov_b32 s42, 0xf0f0f0f0
    s_mov_b32 s43, 0xf0f0f0f0
    v_and_b32 v150, 27, v2
    v_cmp_eq_u32 vcc, 16, v150
    v_mov_b32 v150, 0x3f803f80
    v_bfe_u32 v153, v2, 2, 1
    v_lshlrev_b32 v153, 1, v153
    v_sub_u32 v153, 2, v153
    v_cndmask_b32 v128, 0, v150, vcc
    v_mov_b32 v129, v128
    v_mov_b32 v130, v128
    v_mov_b32 v131, v128
    v_mov_b32 v132, v128
    v_mov_b32 v133, v128
    v_mov_b32 v134, v128
    v_mov_b32 v135, v128
    v_mov_b32 v136, v128
    v_mov_b32 v137, v128
    v_mov_b32 v138, v128
    v_mov_b32 v139, v128
    v_mov_b32 v140, v128
    v_mov_b32 v141, v128
    v_mov_b32 v142, v128
    v_mov_b32 v143, v128
    v_mov_b32 v92, 0
    v_mov_b32 v93, 0
    v_mov_b32 v94, 0
    v_mov_b32 v95, 0
    v_mov_b32 v96, 0
    v_mov_b32 v97, 0
    v_mov_b32 v98, 0
    v_mov_b32 v99, 0
    v_mov_b32 v100, 0
    v_mov_b32 v101, 0
    v_mov_b32 v102, 0
    v_mov_b32 v103, 0
    v_mov_b32 v104, 0
    v_mov_b32 v105, 0
    v_mov_b32 v106, 0
    v_mov_b32 v107, 0
    v_mov_b32 v108, 0
    v_mov_b32 v109, 0
    v_mov_b32 v110, 0
    v_mov_b32 v111, 0
    v_mov_b32 v112, 0
    v_mov_b32 v113, 0
    v_mov_b32 v114, 0
    v_mov_b32 v115, 0
    v_mov_b32 v116, 0
    v_mov_b32 v117, 0
    v_mov_b32 v118, 0
    v_mov_b32 v119, 0
    v_mov_b32 v120, 0
    v_mov_b32 v121, 0
    v_mov_b32 v122, 0
    v_mov_b32 v123, 0
    v_mov_b32 v84, 0
    v_mov_b32 v85, 0
    v_mov_b32 v86, 0
    v_mov_b32 v87, 0
    v_mov_b32 v88, 0
    v_mov_b32 v89, 0
    v_mov_b32 v90, 0
    v_mov_b32 v91, 0
    s_cmp_eq_u32 s55, 1
    s_cbranch_scc0 AT_noz
    s_waitcnt vmcnt(0)
    s_mov_b64 exec, 1
    v_mov_b32 v44, 162940
    v_mov_b32 v45, 1
    ds_add_rtn_u32 v44, v44, v45
    v_mov_b32 v46, 0
    s_waitcnt lgkmcnt(0)
    v_cmp_eq_u32 vcc, 11, v44
    s_nop 0
    s_cbranch_vccz AT_az
    s_mov_b64 exec, 0xff
    v_lshlrev_b32 v46, 11, v2
    v_mov_b32 v45, 1
    buffer_store_dword v45, v46, s[12:15], s54 offen sc1
AT_az:
    s_mov_b64 exec, -1
AT_noz:
    s_cmp_eq_u32 s16, 0
    s_cbranch_scc0 AT_wg
    s_lshr_b32 s36, s17, 2
    s_add_u32 s37, s36, 11
    s_add_u32 s38, s36, 6
    s_cmp_lt_u32 s36, 5
    s_cselect_b32 s37, s37, s38
    s_lshl_b32 s37, s37, 7
    s_add_u32 s38, s36, 8
    s_lshl_b32 s38, s38, 7
    s_lshl_b32 s36, s36, 7
    s_lshl_b32 s39, s18, 3
    s_add_u32 s36, s36, s39
    v_and_b32 v44, 15, v2
    v_lshlrev_b32 v44, 2, v44
    v_and_b32 v45, 4, v44
    v_add_u32 v45, s36, v45
    v_add_u32 v46, s37, v44
    v_add_u32 v44, s38, v44
    s_mov_b64 exec, 0xffff0000
    v_mov_b32 v44, v46
    s_mov_b32 exec_lo, 0
    s_mov_b32 exec_hi, -1
    v_mov_b32 v44, v45
    s_mov_b64 exec, -1
    s_lshl_b32 s36, s18, 11
    s_add_u32 s36, s36, 25165824
    v_add_u32 v44, s36, v44
    v_mov_b32 v46, 162928
AT_wr:
    ds_read_b32 v47, v46
    s_waitcnt lgkmcnt(0)
    v_cmp_gt_u32 vcc, 1, v47
    s_nop 0
    s_cbranch_vccz AT_wr_ok
    s_sleep 2
    s_branch AT_wr
AT_wr_ok:
AT_poll:
    buffer_load_dword v45, v44, s[12:15], 0 offen sc1
    s_waitcnt vmcnt(0)
    v_cmp_ne_u32 vcc, 1, v45
    s_nop 0
    s_cbranch_vccz AT_poll_ok
    s_sleep 4
    s_sub_u32 s63, s63, 1
    s_cbranch_scc0 AT_poll
AT_poll_ok:
    v_mov_b32 v44, 162944
    v_mov_b32 v45, 1
    ds_write_b32 v44, v45
    s_branch AT_go
AT_wg:
    v_mov_b32 v44, 162944
AT_ww:
    ds_read_b32 v45, v44
    s_waitcnt lgkmcnt(0)
    v_cmp_gt_u32 vcc, 1, v45
    s_nop 0
    s_cbranch_vccz AT_ww_ok
    s_sleep 2
    s_branch AT_ww
AT_ww_ok:
AT_go:
    s_setprio 1
    s_sub_u32 s20, s20, 8192
    buffer_load_dwordx4 v[4:7], v152, s[12:15], s22 offen sc1
    buffer_load_dwordx4 v[60:63], v152, s[12:15], s24 offen sc1
    buffer_load_dwordx4 v[8:11], v152, s[12:15], s22 offen offset:1024 sc1
    s_add_u32 m0, s23, 0
    s_add_u32 s20, s20, 8192
    buffer_load_dwordx4 v146, s[12:15], s20 offen sc1 lds
    buffer_load_dwordx4 v146, s[12:15], s20 offen offset:1024 sc1 lds
    s_waitcnt vmcnt(2)
    v_mfma_f32_32x32x16_bf16 v[12:27], v[60:63], v[4:7], 0
    v_mfma_f32_32x32x16_bf16 v[28:43], v[60:63], v[8:11], 0
    s_waitcnt vmcnt(0)
    v_mov_b32 v151, 1
    ds_write_b32 v148, v151
    s_nop 7
    v_max3_f32 v150, v12, v13, v14
    v_max3_f32 v150, v150, v15, v16
    v_max3_f32 v150, v150, v17, v18
    v_max3_f32 v150, v150, v19, v20
    v_max3_f32 v150, v150, v21, v22
    v_max3_f32 v150, v150, v23, v24
    v_max3_f32 v150, v150, v25, v26
    v_max_f32 v150, v150, v27
    v_mov_b32 v149, v150
    s_nop 1
    v_permlane32_swap_b32 v150, v149
    v_max_f32 v150, v150, v149
    v_sub_f32 v12, 0xc2b40000, v150
    v_mov_b32 v13, v12
    v_mov_b32 v14, v12
    v_mov_b32 v15, v12
    v_mov_b32 v16, v12
    v_mov_b32 v17, v12
    v_mov_b32 v18, v12
    v_mov_b32 v19, v12
    v_mov_b32 v20, v12
    v_mov_b32 v21, v12
    v_mov_b32 v22, v12
    v_mov_b32 v23, v12
    v_mov_b32 v24, v12
    v_mov_b32 v25, v12
    v_mov_b32 v26, v12
    v_mov_b32 v27, v12
    v_max3_f32 v150, v28, v29, v30
    v_max3_f32 v150, v150, v31, v32
    v_max3_f32 v150, v150, v33, v34
    v_max3_f32 v150, v150, v35, v36
    v_max3_f32 v150, v150, v37, v38
    v_max3_f32 v150, v150, v39, v40
    v_max3_f32 v150, v150, v41, v42
    v_max_f32 v150, v150, v43
    v_mov_b32 v149, v150
    s_nop 1
    v_permlane32_swap_b32 v150, v149
    v_max_f32 v150, v150, v149
    v_sub_f32 v28, 0xc2b40000, v150
    v_mov_b32 v29, v28
    v_mov_b32 v30, v28
    v_mov_b32 v31, v28
    v_mov_b32 v32, v28
    v_mov_b32 v33, v28
    v_mov_b32 v34, v28
    v_mov_b32 v35, v28
    v_mov_b32 v36, v28
    v_mov_b32 v37, v28
    v_mov_b32 v38, v28
    v_mov_b32 v39, v28
    v_mov_b32 v40, v28
    v_mov_b32 v41, v28
    v_mov_b32 v42, v28
    v_mov_b32 v43, v28
    s_mul_i32 s29, s21, 75
    s_add_u32 s29, s29, s17
    s_lshl_b32 s29, s29, 10
    s_add_u32 s29, s29, 16777216
    s_add_u32 m0, s23, 8192
    s_add_u32 s20, s20, 8192
    buffer_load_dwordx4 v146, s[12:15], s20 offen sc1 lds
    buffer_load_dwordx4 v146, s[12:15], s20 offen offset:1024 sc1 lds
    s_add_u32 m0, s23, 16384
    s_add_u32 s20, s20, 8192
    buffer_load_dwordx4 v146, s[12:15], s20 offen sc1 lds
    buffer_load_dwordx4 v146, s[12:15], s20 offen offset:1024 sc1 lds
AT_spin0:
    ds_read_b32 v149, v147
    s_waitcnt lgkmcnt(0)
    v_cmp_gt_u32 vcc, 1, v149
    s_nop 0
    s_and_b64 vcc, vcc, s[40:41]
    s_cbranch_vccnz AT_spin0
    ds_read_b128 v[124:127], v144
    s_setprio 0
    s_mov_b32 s28, 0
    s_waitcnt lgkmcnt(0)
    v_mfma_f32_32x32x16_bf16 v[44:59], v[124:127], v[4:7], v[12:27]
    s_nop 9
AT_loop:
    v_mfma_f32_32x32x16_bf16 v[60:75], v[124:127], v[8:11], v[28:43]
    ds_read_b128 v[124:127], v144 offset:2048
    s_mov_b64 exec, s[26:27]
    ds_read_b128 v[128:131], v145 offset:0
    ds_read_b128 v[132:135], v145 offset:512
    s_mov_b64 exec, -1
    v_exp_f32 v44, v44
    v_exp_f32 v45, v45
    v_exp_f32 v46, v46
    v_exp_f32 v47, v47
    v_cvt_pk_bf16_f32 v76, v44, v45
    v_exp_f32 v48, v48
    v_mfma_f32_32x32x16_bf16 v[108:123], v[136:139], v[84:87], v[108:123]
    v_exp_f32 v49, v49
    v_cvt_pk_bf16_f32 v77, v46, v47
    v_exp_f32 v50, v50
    v_exp_f32 v51, v51
    v_cvt_pk_bf16_f32 v78, v48, v49
    v_exp_f32 v52, v52
    v_exp_f32 v53, v53
    v_cvt_pk_bf16_f32 v79, v50, v51
    v_exp_f32 v54, v54
    v_mfma_f32_32x32x16_bf16 v[108:123], v[140:143], v[88:91], v[108:123]
    v_exp_f32 v55, v55
    v_cvt_pk_bf16_f32 v80, v52, v53
    v_exp_f32 v56, v56
    v_exp_f32 v57, v57
    v_cvt_pk_bf16_f32 v81, v54, v55
    v_exp_f32 v58, v58
    v_exp_f32 v59, v59
    v_cvt_pk_bf16_f32 v82, v56, v57
    v_cvt_pk_bf16_f32 v83, v58, v59
    s_waitcnt lgkmcnt(0)
    v_mfma_f32_32x32x16_bf16 v[44:59], v[124:127], v[4:7], v[12:27]
    v_exp_f32 v60, v60
    v_exp_f32 v61, v61
    v_exp_f32 v62, v62
    v_exp_f32 v63, v63
    v_cvt_pk_bf16_f32 v84, v60, v61
    v_exp_f32 v64, v64
    v_mfma_f32_32x32x16_bf16 v[92:107], v[128:131], v[76:79], v[92:107]
    v_exp_f32 v65, v65
    v_cvt_pk_bf16_f32 v85, v62, v63
    v_exp_f32 v66, v66
    v_exp_f32 v67, v67
    v_cvt_pk_bf16_f32 v86, v64, v65
    v_exp_f32 v68, v68
    v_exp_f32 v69, v69
    v_cvt_pk_bf16_f32 v87, v66, v67
    v_exp_f32 v70, v70
    v_mfma_f32_32x32x16_bf16 v[92:107], v[132:135], v[80:83], v[92:107]
    v_exp_f32 v71, v71
    v_cvt_pk_bf16_f32 v88, v68, v69
    v_exp_f32 v72, v72
    v_exp_f32 v73, v73
    v_cvt_pk_bf16_f32 v89, v70, v71
    v_exp_f32 v74, v74
    v_exp_f32 v75, v75
    v_cvt_pk_bf16_f32 v90, v72, v73
    v_cvt_pk_bf16_f32 v91, v74, v75
    v_mfma_f32_32x32x16_bf16 v[60:75], v[124:127], v[8:11], v[28:43]
    ds_read_b128 v[124:127], v144 offset:4096
    s_mov_b64 exec, s[26:27]
    ds_read_b128 v[136:139], v145 offset:2048
    ds_read_b128 v[140:143], v145 offset:2560
    s_mov_b64 exec, -1
    v_add_u32 v150, 1, v151
    s_waitcnt vmcnt(2)
    ds_write_b32 v148, v150
    v_exp_f32 v44, v44
    v_exp_f32 v45, v45
    v_exp_f32 v46, v46
    v_exp_f32 v47, v47
    v_cvt_pk_bf16_f32 v76, v44, v45
    v_exp_f32 v48, v48
    v_mfma_f32_32x32x16_bf16 v[108:123], v[128:131], v[84:87], v[108:123]
    v_exp_f32 v49, v49
    v_cvt_pk_bf16_f32 v77, v46, v47
    v_exp_f32 v50, v50
    v_exp_f32 v51, v51
    v_cvt_pk_bf16_f32 v78, v48, v49
    v_exp_f32 v52, v52
    v_exp_f32 v53, v53
    v_cvt_pk_bf16_f32 v79, v50, v51
    v_exp_f32 v54, v54
    v_mfma_f32_32x32x16_bf16 v[108:123], v[132:135], v[88:91], v[108:123]
    v_exp_f32 v55, v55
    v_cvt_pk_bf16_f32 v80, v52, v53
    v_exp_f32 v56, v56
    v_exp_f32 v57, v57
    v_cvt_pk_bf16_f32 v81, v54, v55
    v_exp_f32 v58, v58
    v_exp_f32 v59, v59
    v_cvt_pk_bf16_f32 v82, v56, v57
    v_cvt_pk_bf16_f32 v83, v58, v59
    s_waitcnt lgkmcnt(0)
    v_mfma_f32_32x32x16_bf16 v[44:59], v[124:127], v[4:7], v[12:27]
    v_exp_f32 v60, v60
    v_exp_f32 v61, v61
    v_exp_f32 v62, v62
    v_exp_f32 v63, v63
    v_cvt_pk_bf16_f32 v84, v60, v61
    v_exp_f32 v64, v64
    v_mfma_f32_32x32x16_bf16 v[92:107], v[136:139], v[76:79], v[92:107]
    v_exp_f32 v65, v65
    v_cvt_pk_bf16_f32 v85, v62, v63
    v_exp_f32 v66, v66
    v_exp_f32 v67, v67
    v_cvt_pk_bf16_f32 v86, v64, v65
    v_exp_f32 v68, v68
    v_exp_f32 v69, v69
    v_cvt_pk_bf16_f32 v87, v66, v67
    v_exp_f32 v70, v70
    v_mfma_f32_32x32x16_bf16 v[92:107], v[140:143], v[80:83], v[92:107]
    v_exp_f32 v71, v71
    v_cvt_pk_bf16_f32 v88, v68, v69
    v_exp_f32 v72, v72
    v_exp_f32 v73, v73
    v_cvt_pk_bf16_f32 v89, v70, v71
    v_exp_f32 v74, v74
    v_exp_f32 v75, v75
    v_cvt_pk_bf16_f32 v90, v72, v73
    v_cvt_pk_bf16_f32 v91, v74, v75
    v_mfma_f32_32x32x16_bf16 v[60:75], v[124:127], v[8:11], v[28:43]
    ds_read_b128 v[124:127], v144 offset:6144
    s_mov_b64 exec, s[26:27]
    ds_read_b128 v[128:131], v145 offset:4096
    ds_read_b128 v[132:135], v145 offset:4608
    s_mov_b64 exec, -1
    ds_read_b32 v149, v147
    v_exp_f32 v44, v44
    v_exp_f32 v45, v45
    v_exp_f32 v46, v46
    v_exp_f32 v47, v47
    v_cvt_pk_bf16_f32 v76, v44, v45
    v_exp_f32 v48, v48
    v_mfma_f32_32x32x16_bf16 v[108:123], v[136:139], v[84:87], v[108:123]
    v_exp_f32 v49, v49
    v_cvt_pk_bf16_f32 v77, v46, v47
    v_exp_f32 v50, v50
    v_exp_f32 v51, v51
    v_cvt_pk_bf16_f32 v78, v48, v49
    v_exp_f32 v52, v52
    v_exp_f32 v53, v53
    v_cvt_pk_bf16_f32 v79, v50, v51
    v_exp_f32 v54, v54
    v_mfma_f32_32x32x16_bf16 v[108:123], v[140:143], v[88:91], v[108:123]
    v_exp_f32 v55, v55
    v_cvt_pk_bf16_f32 v80, v52, v53
    v_exp_f32 v56, v56
    v_exp_f32 v57, v57
    v_cvt_pk_bf16_f32 v81, v54, v55
    v_exp_f32 v58, v58
    v_exp_f32 v59, v59
    v_cvt_pk_bf16_f32 v82, v56, v57
    v_cvt_pk_bf16_f32 v83, v58, v59
    s_waitcnt lgkmcnt(0)
    v_mfma_f32_32x32x16_bf16 v[44:59], v[124:127], v[4:7], v[12:27]
    v_exp_f32 v60, v60
    v_exp_f32 v61, v61
    v_exp_f32 v62, v62
    v_exp_f32 v63, v63
    v_cvt_pk_bf16_f32 v84, v60, v61
    v_exp_f32 v64, v64
    v_mfma_f32_32x32x16_bf16 v[92:107], v[128:131], v[76:79], v[92:107]
    v_exp_f32 v65, v65
    v_cvt_pk_bf16_f32 v85, v62, v63
    v_exp_f32 v66, v66
    v_exp_f32 v67, v67
    v_cvt_pk_bf16_f32 v86, v64, v65
    v_exp_f32 v68, v68
    v_exp_f32 v69, v69
    v_cvt_pk_bf16_f32 v87, v66, v67
    v_exp_f32 v70, v70
    v_mfma_f32_32x32x16_bf16 v[92:107], v[132:135], v[80:83], v[92:107]
    v_exp_f32 v71, v71
    v_cvt_pk_bf16_f32 v88, v68, v69
    v_exp_f32 v72, v72
    v_exp_f32 v73, v73
    v_cvt_pk_bf16_f32 v89, v70, v71
    v_exp_f32 v74, v74
    v_exp_f32 v75, v75
    v_cvt_pk_bf16_f32 v90, v72, v73
    v_cvt_pk_bf16_f32 v91, v74, v75
    v_cmp_gt_u32 vcc, v153, v149
    v_add_u32 v153, 1, v153
    s_cbranch_vccnz AT_slow0
AT_back0:
    v_mfma_f32_32x32x16_bf16 v[60:75], v[124:127], v[8:11], v[28:43]
    ds_read_b128 v[124:127], v144 offset:8192
    s_mov_b64 exec, s[26:27]
    ds_read_b128 v[136:139], v145 offset:6144
    ds_read_b128 v[140:143], v145 offset:6656
    s_mov_b64 exec, -1
    ds_write_b32 v148, v151 offset:16
    s_add_u32 m0, s23, 24576
    s_add_u32 s20, s20, 8192
    buffer_load_dwordx4 v146, s[12:15], s20 offen sc1 lds
    buffer_load_dwordx4 v146, s[12:15], s20 offen offset:1024 sc1 lds
    v_exp_f32 v44, v44
    v_exp_f32 v45, v45
    v_exp_f32 v46, v46
    v_exp_f32 v47, v47
    v_cvt_pk_bf16_f32 v76, v44, v45
    v_exp_f32 v48, v48
    v_mfma_f32_32x32x16_bf16 v[108:123], v[128:131], v[84:87], v[108:123]
    v_exp_f32 v49, v49
    v_cvt_pk_bf16_f32 v77, v46, v47
    v_exp_f32 v50, v50
    v_exp_f32 v51, v51
    v_cvt_pk_bf16_f32 v78, v48, v49
    v_exp_f32 v52, v52
    v_exp_f32 v53, v53
    v_cvt_pk_bf16_f32 v79, v50, v51
    v_exp_f32 v54, v54
    v_mfma_f32_32x32x16_bf16 v[108:123], v[132:135], v[88:91], v[108:123]
    v_exp_f32 v55, v55
    v_cvt_pk_bf16_f32 v80, v52, v53
    v_exp_f32 v56, v56
    v_exp_f32 v57, v57
    v_cvt_pk_bf16_f32 v81, v54, v55
    v_exp_f32 v58, v58
    v_exp_f32 v59, v59
    v_cvt_pk_bf16_f32 v82, v56, v57
    v_cvt_pk_bf16_f32 v83, v58, v59
    s_waitcnt lgkmcnt(0)
    v_mfma_f32_32x32x16_bf16 v[44:59], v[124:127], v[4:7], v[12:27]
    v_add_u32 v151, 1, v151
    v_exp_f32 v60, v60
    v_exp_f32 v61, v61
    v_exp_f32 v62, v62
    v_exp_f32 v63, v63
    v_cvt_pk_bf16_f32 v84, v60, v61
    v_exp_f32 v64, v64
    v_mfma_f32_32x32x16_bf16 v[92:107], v[136:139], v[76:79], v[92:107]
    v_exp_f32 v65, v65
    v_cvt_pk_bf16_f32 v85, v62, v63
    v_exp_f32 v66, v66
    v_exp_f32 v67, v67
    v_cvt_pk_bf16_f32 v86, v64, v65
    v_exp_f32 v68, v68
    v_exp_f32 v69, v69
    v_cvt_pk_bf16_f32 v87, v66, v67
    v_exp_f32 v70, v70
    v_mfma_f32_32x32x16_bf16 v[92:107], v[140:143], v[80:83], v[92:107]
    v_exp_f32 v71, v71
    v_cvt_pk_bf16_f32 v88, v68, v69
    v_exp_f32 v72, v72
    v_exp_f32 v73, v73
    v_cvt_pk_bf16_f32 v89, v70, v71
    v_exp_f32 v74, v74
    v_exp_f32 v75, v75
    v_cvt_pk_bf16_f32 v90, v72, v73
    v_cvt_pk_bf16_f32 v91, v74, v75
    v_mfma_f32_32x32x16_bf16 v[60:75], v[124:127], v[8:11], v[28:43]
    ds_read_b128 v[124:127], v144 offset:10240
    s_mov_b64 exec, s[26:27]
    ds_read_b128 v[128:131], v145 offset:8192
    ds_read_b128 v[132:135], v145 offset:8704
    s_mov_b64 exec, -1
    v_exp_f32 v44, v44
    v_exp_f32 v45, v45
    v_exp_f32 v46, v46
    v_exp_f32 v47, v47
    v_cvt_pk_bf16_f32 v76, v44, v45
    v_exp_f32 v48, v48
    v_mfma_f32_32x32x16_bf16 v[108:123], v[136:139], v[84:87], v[108:123]
    v_exp_f32 v49, v49
    v_cvt_pk_bf16_f32 v77, v46, v47
    v_exp_f32 v50, v50
    v_exp_f32 v51, v51
    v_cvt_pk_bf16_f32 v78, v48, v49
    v_exp_f32 v52, v52
    v_exp_f32 v53, v53
    v_cvt_pk_bf16_f32 v79, v50, v51
    v_exp_f32 v54, v54
    v_mfma_f32_32x32x16_bf16 v[108:123], v[140:143], v[88:91], v[108:123]
    v_exp_f32 v55, v55
    v_cvt_pk_bf16_f32 v80, v52, v53
    v_exp_f32 v56, v56
    v_exp_f32 v57, v57
    v_cvt_pk_bf16_f32 v81, v54, v55
    v_exp_f32 v58, v58
    v_exp_f32 v59, v59
    v_cvt_pk_bf16_f32 v82, v56, v57
    v_cvt_pk_bf16_f32 v83, v58, v59
    s_waitcnt lgkmcnt(0)
    v_mfma_f32_32x32x16_bf16 v[44:59], v[124:127], v[4:7], v[12:27]
    v_exp_f32 v60, v60
    v_exp_f32 v61, v61
    v_exp_f32 v62, v62
    v_exp_f32 v63, v63
    v_cvt_pk_bf16_f32 v84, v60, v61
    v_exp_f32 v64, v64
    v_mfma_f32_32x32x16_bf16 v[92:107], v[128:131], v[76:79], v[92:107]
    v_exp_f32 v65, v65
    v_cvt_pk_bf16_f32 v85, v62, v63
    v_exp_f32 v66, v66
    v_exp_f32 v67, v67
    v_cvt_pk_bf16_f32 v86, v64, v65
    v_exp_f32 v68, v68
    v_exp_f32 v69, v69
    v_cvt_pk_bf16_f32 v87, v66, v67
    v_exp_f32 v70, v70
    v_mfma_f32_32x32x16_bf16 v[92:107], v[132:135], v[80:83], v[92:107]
    v_exp_f32 v71, v71
    v_cvt_pk_bf16_f32 v88, v68, v69
    v_exp_f32 v72, v72
    v_exp_f32 v73, v73
    v_cvt_pk_bf16_f32 v89, v70, v71
    v_exp_f32 v74, v74
    v_exp_f32 v75, v75
    v_cvt_pk_bf16_f32 v90, v72, v73
    v_cvt_pk_bf16_f32 v91, v74, v75
    v_mfma_f32_32x32x16_bf16 v[60:75], v[124:127], v[8:11], v[28:43]
    ds_read_b128 v[124:127], v144 offset:12288
    s_mov_b64 exec, s[26:27]
    ds_read_b128 v[136:139], v145 offset:10240
    ds_read_b128 v[140:143], v145 offset:10752
    s_mov_b64 exec, -1
    v_add_u32 v150, 1, v151
    s_waitcnt vmcnt(2)
    ds_write_b32 v148, v150
    s_or_b32 s36, s28, s33
    s_cbranch_scc0 AT_f1
AT_fback1:
    v_exp_f32 v44, v44
    v_exp_f32 v45, v45
    v_exp_f32 v46, v46
    v_exp_f32 v47, v47
    v_cvt_pk_bf16_f32 v76, v44, v45
    v_exp_f32 v48, v48
    v_mfma_f32_32x32x16_bf16 v[108:123], v[128:131], v[84:87], v[108:123]
    v_exp_f32 v49, v49
    v_cvt_pk_bf16_f32 v77, v46, v47
    v_exp_f32 v50, v50
    v_exp_f32 v51, v51
    v_cvt_pk_bf16_f32 v78, v48, v49
    v_exp_f32 v52, v52
    v_exp_f32 v53, v53
    v_cvt_pk_bf16_f32 v79, v50, v51
    v_exp_f32 v54, v54
    v_mfma_f32_32x32x16_bf16 v[108:123], v[132:135], v[88:91], v[108:123]
    v_exp_f32 v55, v55
    v_cvt_pk_bf16_f32 v80, v52, v53
    v_exp_f32 v56, v56
    v_exp_f32 v57, v57
    v_cvt_pk_bf16_f32 v81, v54, v55
    v_exp_f32 v58, v58
    v_exp_f32 v59, v59
    v_cvt_pk_bf16_f32 v82, v56, v57
    v_cvt_pk_bf16_f32 v83, v58, v59
    s_waitcnt lgkmcnt(0)
    v_mfma_f32_32x32x16_bf16 v[44:59], v[124:127], v[4:7], v[12:27]
    v_exp_f32 v60, v60
    v_exp_f32 v61, v61
    v_exp_f32 v62, v62
    v_exp_f32 v63, v63
    v_cvt_pk_bf16_f32 v84, v60, v61
    v_exp_f32 v64, v64
    v_mfma_f32_32x32x16_bf16 v[92:107], v[136:139], v[76:79], v[92:107]
    v_exp_f32 v65, v65
    v_cvt_pk_bf16_f32 v85, v62, v63
    v_exp_f32 v66, v66
    v_exp_f32 v67, v67
    v_cvt_pk_bf16_f32 v86, v64, v65
    v_exp_f32 v68, v68
    v_exp_f32 v69, v69
    v_cvt_pk_bf16_f32 v87, v66, v67
    v_exp_f32 v70, v70
    v_mfma_f32_32x32x16_bf16 v[92:107], v[140:143], v[80:83], v[92:107]
    v_exp_f32 v71, v71
    v_cvt_pk_bf16_f32 v88, v68, v69
    v_exp_f32 v72, v72
    v_exp_f32 v73, v73
    v_cvt_pk_bf16_f32 v89, v70, v71
    v_exp_f32 v74, v74
    v_exp_f32 v75, v75
    v_cvt_pk_bf16_f32 v90, v72, v73
    v_cvt_pk_bf16_f32 v91, v74, v75
    v_mfma_f32_32x32x16_bf16 v[60:75], v[124:127], v[8:11], v[28:43]
    ds_read_b128 v[124:127], v144 offset:14336
    s_mov_b64 exec, s[26:27]
    ds_read_b128 v[128:131], v145 offset:12288
    ds_read_b128 v[132:135], v145 offset:12800
    s_mov_b64 exec, -1
    ds_read_b32 v149, v147
    v_exp_f32 v44, v44
    v_exp_f32 v45, v45
    v_exp_f32 v46, v46
    v_exp_f32 v47, v47
    v_cvt_pk_bf16_f32 v76, v44, v45
    v_exp_f32 v48, v48
    v_mfma_f32_32x32x16_bf16 v[108:123], v[136:139], v[84:87], v[108:123]
    v_exp_f32 v49, v49
    v_cvt_pk_bf16_f32 v77, v46, v47
    v_exp_f32 v50, v50
    v_exp_f32 v51, v51
    v_cvt_pk_bf16_f32 v78, v48, v49
    v_exp_f32 v52, v52
    v_exp_f32 v53, v53
    v_cvt_pk_bf16_f32 v79, v50, v51
    v_exp_f32 v54, v54
    v_mfma_f32_32x32x16_bf16 v[108:123], v[140:143], v[88:91], v[108:123]
    v_exp_f32 v55, v55
    v_cvt_pk_bf16_f32 v80, v52, v53
    v_exp_f32 v56, v56
    v_exp_f32 v57, v57
    v_cvt_pk_bf16_f32 v81, v54, v55
    v_exp_f32 v58, v58
    v_exp_f32 v59, v59
    v_cvt_pk_bf16_f32 v82, v56, v57
    v_cvt_pk_bf16_f32 v83, v58, v59
    s_waitcnt lgkmcnt(0)
    v_mfma_f32_32x32x16_bf16 v[44:59], v[124:127], v[4:7], v[12:27]
    v_exp_f32 v60, v60
    v_exp_f32 v61, v61
    v_exp_f32 v62, v62
    v_exp_f32 v63, v63
    v_cvt_pk_bf16_f32 v84, v60, v61
    v_exp_f32 v64, v64
    v_mfma_f32_32x32x16_bf16 v[92:107], v[128:131], v[76:79], v[92:107]
    v_exp_f32 v65, v65
    v_cvt_pk_bf16_f32 v85, v62, v63
    v_exp_f32 v66, v66
    v_exp_f32 v67, v67
    v_cvt_pk_bf16_f32 v86, v64, v65
    v_exp_f32 v68, v68
    v_exp_f32 v69, v69
    v_cvt_pk_bf16_f32 v87, v66, v67
    v_exp_f32 v70, v70
    v_mfma_f32_32x32x16_bf16 v[92:107], v[132:135], v[80:83], v[92:107]
    v_exp_f32 v71, v71
    v_cvt_pk_bf16_f32 v88, v68, v69
    v_exp_f32 v72, v72
    v_exp_f32 v73, v73
    v_cvt_pk_bf16_f32 v89, v70, v71
    v_exp_f32 v74, v74
    v_exp_f32 v75, v75
    v_cvt_pk_bf16_f32 v90, v72, v73
    v_cvt_pk_bf16_f32 v91, v74, v75
    v_cmp_gt_u32 vcc, v153, v149
    v_add_u32 v153, 1, v153
    s_cbranch_vccnz AT_slow1
AT_back1:
    v_mfma_f32_32x32x16_bf16 v[60:75], v[124:127], v[8:11], v[28:43]
    ds_read_b128 v[124:127], v144 offset:16384
    s_mov_b64 exec, s[26:27]
    ds_read_b128 v[136:139], v145 offset:14336
    ds_read_b128 v[140:143], v145 offset:14848
    s_mov_b64 exec, -1
    ds_write_b32 v148, v151 offset:16
    s_cmp_eq_u32 s28, 0
    s_cbranch_scc0 AT_nodma1
    s_add_u32 m0, s23, 0
    s_add_u32 s20, s20, 8192
    buffer_load_dwordx4 v146, s[12:15], s20 offen sc1 lds
    buffer_load_dwordx4 v146, s[12:15], s20 offen offset:1024 sc1 lds
AT_dmaback1:
    v_exp_f32 v44, v44
    v_exp_f32 v45, v45
    v_exp_f32 v46, v46
    v_exp_f32 v47, v47
    v_cvt_pk_bf16_f32 v76, v44, v45
    v_exp_f32 v48, v48
    v_mfma_f32_32x32x16_bf16 v[108:123], v[128:131], v[84:87], v[108:123]
    v_exp_f32 v49, v49
    v_cvt_pk_bf16_f32 v77, v46, v47
    v_exp_f32 v50, v50
    v_exp_f32 v51, v51
    v_cvt_pk_bf16_f32 v78, v48, v49
    v_exp_f32 v52, v52
    v_exp_f32 v53, v53
    v_cvt_pk_bf16_f32 v79, v50, v51
    v_exp_f32 v54, v54
    v_mfma_f32_32x32x16_bf16 v[108:123], v[132:135], v[88:91], v[108:123]
    v_exp_f32 v55, v55
    v_cvt_pk_bf16_f32 v80, v52, v53
    v_exp_f32 v56, v56
    v_exp_f32 v57, v57
    v_cvt_pk_bf16_f32 v81, v54, v55
    v_exp_f32 v58, v58
    v_exp_f32 v59, v59
    v_cvt_pk_bf16_f32 v82, v56, v57
    v_cvt_pk_bf16_f32 v83, v58, v59
    s_waitcnt lgkmcnt(0)
    v_mfma_f32_32x32x16_bf16 v[44:59], v[124:127], v[4:7], v[12:27]
    v_add_u32 v151, 1, v151
    v_exp_f32 v60, v60
    v_exp_f32 v61, v61
    v_exp_f32 v62, v62
    v_exp_f32 v63, v63
    v_cvt_pk_bf16_f32 v84, v60, v61
    v_exp_f32 v64, v64
    v_mfma_f32_32x32x16_bf16 v[92:107], v[136:139], v[76:79], v[92:107]
    v_exp_f32 v65, v65
    v_cvt_pk_bf16_f32 v85, v62, v63
    v_exp_f32 v66, v66
    v_exp_f32 v67, v67
    v_cvt_pk_bf16_f32 v86, v64, v65
    v_exp_f32 v68, v68
    v_exp_f32 v69, v69
    v_cvt_pk_bf16_f32 v87, v66, v67
    v_exp_f32 v70, v70
    v_mfma_f32_32x32x16_bf16 v[92:107], v[140:143], v[80:83], v[92:107]
    v_exp_f32 v71, v71
    v_cvt_pk_bf16_f32 v88, v68, v69
    v_exp_f32 v72, v72
    v_exp_f32 v73, v73
    v_cvt_pk_bf16_f32 v89, v70, v71
    v_exp_f32 v74, v74
    v_exp_f32 v75, v75
    v_cvt_pk_bf16_f32 v90, v72, v73
    v_cvt_pk_bf16_f32 v91, v74, v75
    v_mfma_f32_32x32x16_bf16 v[60:75], v[124:127], v[8:11], v[28:43]
    ds_read_b128 v[124:127], v144 offset:18432
    s_mov_b64 exec, s[26:27]
    ds_read_b128 v[128:131], v145 offset:16384
    ds_read_b128 v[132:135], v145 offset:16896
    s_mov_b64 exec, -1
    v_exp_f32 v44, v44
    v_exp_f32 v45, v45
    v_exp_f32 v46, v46
    v_exp_f32 v47, v47
    v_cvt_pk_bf16_f32 v76, v44, v45
    v_exp_f32 v48, v48
    v_mfma_f32_32x32x16_bf16 v[108:123], v[136:139], v[84:87], v[108:123]
    v_exp_f32 v49, v49
    v_cvt_pk_bf16_f32 v77, v46, v47
    v_exp_f32 v50, v50
    v_exp_f32 v51, v51
    v_cvt_pk_bf16_f32 v78, v48, v49
    v_exp_f32 v52, v52
    v_exp_f32 v53, v53
    v_cvt_pk_bf16_f32 v79, v50, v51
    v_exp_f32 v54, v54
    v_mfma_f32_32x32x16_bf16 v[108:123], v[140:143], v[88:91], v[108:123]
    v_exp_f32 v55, v55
    v_cvt_pk_bf16_f32 v80, v52, v53
    v_exp_f32 v56, v56
    v_exp_f32 v57, v57
    v_cvt_pk_bf16_f32 v81, v54, v55
    v_exp_f32 v58, v58
    v_exp_f32 v59, v59
    v_cvt_pk_bf16_f32 v82, v56, v57
    v_cvt_pk_bf16_f32 v83, v58, v59
    s_waitcnt lgkmcnt(0)
    v_mfma_f32_32x32x16_bf16 v[44:59], v[124:127], v[4:7], v[12:27]
    v_exp_f32 v60, v60
    v_exp_f32 v61, v61
    v_exp_f32 v62, v62
    v_exp_f32 v63, v63
    v_cvt_pk_bf16_f32 v84, v60, v61
    v_exp_f32 v64, v64
    v_mfma_f32_32x32x16_bf16 v[92:107], v[128:131], v[76:79], v[92:107]
    v_exp_f32 v65, v65
    v_cvt_pk_bf16_f32 v85, v62, v63
    v_exp_f32 v66, v66
    v_exp_f32 v67, v67
    v_cvt_pk_bf16_f32 v86, v64, v65
    v_exp_f32 v68, v68
    v_exp_f32 v69, v69
    v_cvt_pk_bf16_f32 v87, v66, v67
    v_exp_f32 v70, v70
    v_mfma_f32_32x32x16_bf16 v[92:107], v[132:135], v[80:83], v[92:107]
    v_exp_f32 v71, v71
    v_cvt_pk_bf16_f32 v88, v68, v69
    v_exp_f32 v72, v72
    v_exp_f32 v73, v73
    v_cvt_pk_bf16_f32 v89, v70, v71
    v_exp_f32 v74, v74
    v_exp_f32 v75, v75
    v_cvt_pk_bf16_f32 v90, v72, v73
    v_cvt_pk_bf16_f32 v91, v74, v75
    v_mfma_f32_32x32x16_bf16 v[60:75], v[124:127], v[8:11], v[28:43]
    ds_read_b128 v[124:127], v144 offset:20480
    s_mov_b64 exec, s[26:27]
    ds_read_b128 v[136:139], v145 offset:18432
    ds_read_b128 v[140:143], v145 offset:18944
    s_mov_b64 exec, -1
    v_add_u32 v150, 1, v151
    s_waitcnt vmcnt(2)
    ds_write_b32 v148, v150
    v_exp_f32 v44, v44
    v_exp_f32 v45, v45
    v_exp_f32 v46, v46
    v_exp_f32 v47, v47
    v_cvt_pk_bf16_f32 v76, v44, v45
    v_exp_f32 v48, v48
    v_mfma_f32_32x32x16_bf16 v[108:123], v[128:131], v[84:87], v[108:123]
    v_exp_f32 v49, v49
    v_cvt_pk_bf16_f32 v77, v46, v47
    v_exp_f32 v50, v50
    v_exp_f32 v51, v51
    v_cvt_pk_bf16_f32 v78, v48, v49
    v_exp_f32 v52, v52
    v_exp_f32 v53, v53
    v_cvt_pk_bf16_f32 v79, v50, v51
    v_exp_f32 v54, v54
    v_mfma_f32_32x32x16_bf16 v[108:123], v[132:135], v[88:91], v[108:123]
    v_exp_f32 v55, v55
    v_cvt_pk_bf16_f32 v80, v52, v53
    v_exp_f32 v56, v56
    v_exp_f32 v57, v57
    v_cvt_pk_bf16_f32 v81, v54, v55
    v_exp_f32 v58, v58
    v_exp_f32 v59, v59
    v_cvt_pk_bf16_f32 v82, v56, v57
    v_cvt_pk_bf16_f32 v83, v58, v59
    s_waitcnt lgkmcnt(0)
    v_mfma_f32_32x32x16_bf16 v[44:59], v[124:127], v[4:7], v[12:27]
    v_exp_f32 v60, v60
    v_exp_f32 v61, v61
    v_exp_f32 v62, v62
    v_exp_f32 v63, v63
    v_cvt_pk_bf16_f32 v84, v60, v61
    v_exp_f32 v64, v64
    v_mfma_f32_32x32x16_bf16 v[92:107], v[136:139], v[76:79], v[92:107]
    v_exp_f32 v65, v65
    v_cvt_pk_bf16_f32 v85, v62, v63
    v_exp_f32 v66, v66
    v_exp_f32 v67, v67
    v_cvt_pk_bf16_f32 v86, v64, v65
    v_exp_f32 v68, v68
    v_exp_f32 v69, v69
    v_cvt_pk_bf16_f32 v87, v66, v67
    v_exp_f32 v70, v70
    v_mfma_f32_32x32x16_bf16 v[92:107], v[140:143], v[80:83], v[92:107]
    v_exp_f32 v71, v71
    v_cvt_pk_bf16_f32 v88, v68, v69
    v_exp_f32 v72, v72
    v_exp_f32 v73, v73
    v_cvt_pk_bf16_f32 v89, v70, v71
    v_exp_f32 v74, v74
    v_exp_f32 v75, v75
    v_cvt_pk_bf16_f32 v90, v72, v73
    v_cvt_pk_bf16_f32 v91, v74, v75
    v_mfma_f32_32x32x16_bf16 v[60:75], v[124:127], v[8:11], v[28:43]
    ds_read_b128 v[124:127], v144 offset:22528
    s_mov_b64 exec, s[26:27]
    ds_read_b128 v[128:131], v145 offset:20480
    ds_read_b128 v[132:135], v145 offset:20992
    s_mov_b64 exec, -1
    ds_read_b32 v149, v147
    v_exp_f32 v44, v44
    v_exp_f32 v45, v45
    v_exp_f32 v46, v46
    v_exp_f32 v47, v47
    v_cvt_pk_bf16_f32 v76, v44, v45
    v_exp_f32 v48, v48
    v_mfma_f32_32x32x16_bf16 v[108:123], v[136:139], v[84:87], v[108:123]
    v_exp_f32 v49, v49
    v_cvt_pk_bf16_f32 v77, v46, v47
    v_exp_f32 v50, v50
    v_exp_f32 v51, v51
    v_cvt_pk_bf16_f32 v78, v48, v49
    v_exp_f32 v52, v52
    v_exp_f32 v53, v53
    v_cvt_pk_bf16_f32 v79, v50, v51
    v_exp_f32 v54, v54
    v_mfma_f32_32x32x16_bf16 v[108:123], v[140:143], v[88:91], v[108:123]
    v_exp_f32 v55, v55
    v_cvt_pk_bf16_f32 v80, v52, v53
    v_exp_f32 v56, v56
    v_exp_f32 v57, v57
    v_cvt_pk_bf16_f32 v81, v54, v55
    v_exp_f32 v58, v58
    v_exp_f32 v59, v59
    v_cvt_pk_bf16_f32 v82, v56, v57
    v_cvt_pk_bf16_f32 v83, v58, v59
    s_waitcnt lgkmcnt(0)
    v_mfma_f32_32x32x16_bf16 v[44:59], v[124:127], v[4:7], v[12:27]
    v_exp_f32 v60, v60
    v_exp_f32 v61, v61
    v_exp_f32 v62, v62
    v_exp_f32 v63, v63
    v_cvt_pk_bf16_f32 v84, v60, v61
    v_exp_f32 v64, v64
    v_mfma_f32_32x32x16_bf16 v[92:107], v[128:131], v[76:79], v[92:107]
    v_exp_f32 v65, v65
    v_cvt_pk_bf16_f32 v85, v62, v63
    v_exp_f32 v66, v66
    v_exp_f32 v67, v67
    v_cvt_pk_bf16_f32 v86, v64, v65
    v_exp_f32 v68, v68
    v_exp_f32 v69, v69
    v_cvt_pk_bf16_f32 v87, v66, v67
    v_exp_f32 v70, v70
    v_mfma_f32_32x32x16_bf16 v[92:107], v[132:135], v[80:83], v[92:107]
    v_exp_f32 v71, v71
    v_cvt_pk_bf16_f32 v88, v68, v69
    v_exp_f32 v72, v72
    v_exp_f32 v73, v73
    v_cvt_pk_bf16_f32 v89, v70, v71
    v_exp_f32 v74, v74
    v_exp_f32 v75, v75
    v_cvt_pk_bf16_f32 v90, v72, v73
    v_cvt_pk_bf16_f32 v91, v74, v75
    v_cmp_gt_u32 vcc, v153, v149
    v_add_u32 v153, 1, v153
    s_cbranch_vccnz AT_slow2
AT_back2:
    v_mfma_f32_32x32x16_bf16 v[60:75], v[124:127], v[8:11], v[28:43]
    ds_read_b128 v[124:127], v144 offset:24576
    s_mov_b64 exec, s[26:27]
    ds_read_b128 v[136:139], v145 offset:22528
    ds_read_b128 v[140:143], v145 offset:23040
    s_mov_b64 exec, -1
    ds_write_b32 v148, v151 offset:16
    s_cmp_eq_u32 s28, 0
    s_cbranch_scc0 AT_nodma2
    s_add_u32 m0, s23, 8192
    s_add_u32 s20, s20, 8192
    buffer_load_dwordx4 v146, s[12:15], s20 offen sc1 lds
    buffer_load_dwordx4 v146, s[12:15], s20 offen offset:1024 sc1 lds
AT_dmaback2:
    v_exp_f32 v44, v44
    v_exp_f32 v45, v45
    v_exp_f32 v46, v46
    v_exp_f32 v47, v47
    v_cvt_pk_bf16_f32 v76, v44, v45
    v_exp_f32 v48, v48
    v_mfma_f32_32x32x16_bf16 v[108:123], v[128:131], v[84:87], v[108:123]
    v_exp_f32 v49, v49
    v_cvt_pk_bf16_f32 v77, v46, v47
    v_exp_f32 v50, v50
    v_exp_f32 v51, v51
    v_cvt_pk_bf16_f32 v78, v48, v49
    v_exp_f32 v52, v52
    v_exp_f32 v53, v53
    v_cvt_pk_bf16_f32 v79, v50, v51
    v_exp_f32 v54, v54
    v_mfma_f32_32x32x16_bf16 v[108:123], v[132:135], v[88:91], v[108:123]
    v_exp_f32 v55, v55
    v_cvt_pk_bf16_f32 v80, v52, v53
    v_exp_f32 v56, v56
    v_exp_f32 v57, v57
    v_cvt_pk_bf16_f32 v81, v54, v55
    v_exp_f32 v58, v58
    v_exp_f32 v59, v59
    v_cvt_pk_bf16_f32 v82, v56, v57
    v_cvt_pk_bf16_f32 v83, v58, v59
    s_waitcnt lgkmcnt(0)
    v_mfma_f32_32x32x16_bf16 v[44:59], v[124:127], v[4:7], v[12:27]
    v_add_u32 v151, 1, v151
    v_exp_f32 v60, v60
    v_exp_f32 v61, v61
    v_exp_f32 v62, v62
    v_exp_f32 v63, v63
    v_cvt_pk_bf16_f32 v84, v60, v61
    v_exp_f32 v64, v64
    v_mfma_f32_32x32x16_bf16 v[92:107], v[136:139], v[76:79], v[92:107]
    v_exp_f32 v65, v65
    v_cvt_pk_bf16_f32 v85, v62, v63
    v_exp_f32 v66, v66
    v_exp_f32 v67, v67
    v_cvt_pk_bf16_f32 v86, v64, v65
    v_exp_f32 v68, v68
    v_exp_f32 v69, v69
    v_cvt_pk_bf16_f32 v87, v66, v67
    v_exp_f32 v70, v70
    v_mfma_f32_32x32x16_bf16 v[92:107], v[140:143], v[80:83], v[92:107]
    v_exp_f32 v71, v71
    v_cvt_pk_bf16_f32 v88, v68, v69
    v_exp_f32 v72, v72
    v_exp_f32 v73, v73
    v_cvt_pk_bf16_f32 v89, v70, v71
    v_exp_f32 v74, v74
    v_exp_f32 v75, v75
    v_cvt_pk_bf16_f32 v90, v72, v73
    v_cvt_pk_bf16_f32 v91, v74, v75
    v_mfma_f32_32x32x16_bf16 v[60:75], v[124:127], v[8:11], v[28:43]
    ds_read_b128 v[124:127], v144 offset:26624
    s_mov_b64 exec, s[26:27]
    ds_read_b128 v[128:131], v145 offset:24576
    ds_read_b128 v[132:135], v145 offset:25088
    s_mov_b64 exec, -1
    v_exp_f32 v44, v44
    v_exp_f32 v45, v45
    v_exp_f32 v46, v46
    v_exp_f32 v47, v47
    v_cvt_pk_bf16_f32 v76, v44, v45
    v_exp_f32 v48, v48
    v_mfma_f32_32x32x16_bf16 v[108:123], v[136:139], v[84:87], v[108:123]
    v_exp_f32 v49, v49
    v_cvt_pk_bf16_f32 v77, v46, v47
    v_exp_f32 v50, v50
    v_exp_f32 v51, v51
    v_cvt_pk_bf16_f32 v78, v48, v49
    v_exp_f32 v52, v52
    v_exp_f32 v53, v53
    v_cvt_pk_bf16_f32 v79, v50, v51
    v_exp_f32 v54, v54
    v_mfma_f32_32x32x16_bf16 v[108:123], v[140:143], v[88:91], v[108:123]
    v_exp_f32 v55, v55
    v_cvt_pk_bf16_f32 v80, v52, v53
    v_exp_f32 v56, v56
    v_exp_f32 v57, v57
    v_cvt_pk_bf16_f32 v81, v54, v55
    v_exp_f32 v58, v58
    v_exp_f32 v59, v59
    v_cvt_pk_bf16_f32 v82, v56, v57
    v_cvt_pk_bf16_f32 v83, v58, v59
    s_waitcnt lgkmcnt(0)
    v_mfma_f32_32x32x16_bf16 v[44:59], v[124:127], v[4:7], v[12:27]
    v_exp_f32 v60, v60
    v_exp_f32 v61, v61
    v_exp_f32 v62, v62
    v_exp_f32 v63, v63
    v_cvt_pk_bf16_f32 v84, v60, v61
    v_exp_f32 v64, v64
    v_mfma_f32_32x32x16_bf16 v[92:107], v[128:131], v[76:79], v[92:107]
    v_exp_f32 v65, v65
    v_cvt_pk_bf16_f32 v85, v62, v63
    v_exp_f32 v66, v66
    v_exp_f32 v67, v67
    v_cvt_pk_bf16_f32 v86, v64, v65
    v_exp_f32 v68, v68
    v_exp_f32 v69, v69
    v_cvt_pk_bf16_f32 v87, v66, v67
    v_exp_f32 v70, v70
    v_mfma_f32_32x32x16_bf16 v[92:107], v[132:135], v[80:83], v[92:107]
    v_exp_f32 v71, v71
    v_cvt_pk_bf16_f32 v88, v68, v69
    v_exp_f32 v72, v72
    v_exp_f32 v73, v73
    v_cvt_pk_bf16_f32 v89, v70, v71
    v_exp_f32 v74, v74
    v_exp_f32 v75, v75
    v_cvt_pk_bf16_f32 v90, v72, v73
    v_cvt_pk_bf16_f32 v91, v74, v75
    v_mfma_f32_32x32x16_bf16 v[60:75], v[124:127], v[8:11], v[28:43]
    ds_read_b128 v[124:127], v144 offset:28672
    s_mov_b64 exec, s[26:27]
    ds_read_b128 v[136:139], v145 offset:26624
    ds_read_b128 v[140:143], v145 offset:27136
    s_mov_b64 exec, -1
    v_add_u32 v150, 1, v151
    s_waitcnt vmcnt(2)
    ds_write_b32 v148, v150
    s_or_b32 s36, s28, s33
    s_cbranch_scc0 AT_f3
AT_fback3:
    v_exp_f32 v44, v44
    v_exp_f32 v45, v45
    v_exp_f32 v46, v46
    v_exp_f32 v47, v47
    v_cvt_pk_bf16_f32 v76, v44, v45
    v_exp_f32 v48, v48
    v_mfma_f32_32x32x16_bf16 v[108:123], v[128:131], v[84:87], v[108:123]
    v_exp_f32 v49, v49
    v_cvt_pk_bf16_f32 v77, v46, v47
    v_exp_f32 v50, v50
    v_exp_f32 v51, v51
    v_cvt_pk_bf16_f32 v78, v48, v49
    v_exp_f32 v52, v52
    v_exp_f32 v53, v53
    v_cvt_pk_bf16_f32 v79, v50, v51
    v_exp_f32 v54, v54
    v_mfma_f32_32x32x16_bf16 v[108:123], v[132:135], v[88:91], v[108:123]
    v_exp_f32 v55, v55
    v_cvt_pk_bf16_f32 v80, v52, v53
    v_exp_f32 v56, v56
    v_exp_f32 v57, v57
    v_cvt_pk_bf16_f32 v81, v54, v55
    v_exp_f32 v58, v58
    v_exp_f32 v59, v59
    v_cvt_pk_bf16_f32 v82, v56, v57
    v_cvt_pk_bf16_f32 v83, v58, v59
    s_waitcnt lgkmcnt(0)
    v_mfma_f32_32x32x16_bf16 v[44:59], v[124:127], v[4:7], v[12:27]
    v_exp_f32 v60, v60
    v_exp_f32 v61, v61
    v_exp_f32 v62, v62
    v_exp_f32 v63, v63
    v_cvt_pk_bf16_f32 v84, v60, v61
    v_exp_f32 v64, v64
    v_mfma_f32_32x32x16_bf16 v[92:107], v[136:139], v[76:79], v[92:107]
    v_exp_f32 v65, v65
    v_cvt_pk_bf16_f32 v85, v62, v63
    v_exp_f32 v66, v66
    v_exp_f32 v67, v67
    v_cvt_pk_bf16_f32 v86, v64, v65
    v_exp_f32 v68, v68
    v_exp_f32 v69, v69
    v_cvt_pk_bf16_f32 v87, v66, v67
    v_exp_f32 v70, v70
    v_mfma_f32_32x32x16_bf16 v[92:107], v[140:143], v[80:83], v[92:107]
    v_exp_f32 v71, v71
    v_cvt_pk_bf16_f32 v88, v68, v69
    v_exp_f32 v72, v72
    v_exp_f32 v73, v73
    v_cvt_pk_bf16_f32 v89, v70, v71
    v_exp_f32 v74, v74
    v_exp_f32 v75, v75
    v_cvt_pk_bf16_f32 v90, v72, v73
    v_cvt_pk_bf16_f32 v91, v74, v75
    v_mfma_f32_32x32x16_bf16 v[60:75], v[124:127], v[8:11], v[28:43]
    ds_read_b128 v[124:127], v144 offset:30720
    s_mov_b64 exec, s[26:27]
    ds_read_b128 v[128:131], v145 offset:28672
    ds_read_b128 v[132:135], v145 offset:29184
    s_mov_b64 exec, -1
    ds_read_b32 v149, v147
    v_exp_f32 v44, v44
    v_exp_f32 v45, v45
    v_exp_f32 v46, v46
    v_exp_f32 v47, v47
    v_cvt_pk_bf16_f32 v76, v44, v45
    v_exp_f32 v48, v48
    v_mfma_f32_32x32x16_bf16 v[108:123], v[136:139], v[84:87], v[108:123]
    v_exp_f32 v49, v49
    v_cvt_pk_bf16_f32 v77, v46, v47
    v_exp_f32 v50, v50
    v_exp_f32 v51, v51
    v_cvt_pk_bf16_f32 v78, v48, v49
    v_exp_f32 v52, v52
    v_exp_f32 v53, v53
    v_cvt_pk_bf16_f32 v79, v50, v51
    v_exp_f32 v54, v54
    v_mfma_f32_32x32x16_bf16 v[108:123], v[140:143], v[88:91], v[108:123]
    v_exp_f32 v55, v55
    v_cvt_pk_bf16_f32 v80, v52, v53
    v_exp_f32 v56, v56
    v_exp_f32 v57, v57
    v_cvt_pk_bf16_f32 v81, v54, v55
    v_exp_f32 v58, v58
    v_exp_f32 v59, v59
    v_cvt_pk_bf16_f32 v82, v56, v57
    v_cvt_pk_bf16_f32 v83, v58, v59
    s_waitcnt lgkmcnt(0)
    v_mfma_f32_32x32x16_bf16 v[44:59], v[124:127], v[4:7], v[12:27]
    v_exp_f32 v60, v60
    v_exp_f32 v61, v61
    v_exp_f32 v62, v62
    v_exp_f32 v63, v63
    v_cvt_pk_bf16_f32 v84, v60, v61
    v_exp_f32 v64, v64
    v_mfma_f32_32x32x16_bf16 v[92:107], v[128:131], v[76:79], v[92:107]
    v_exp_f32 v65, v65
    v_cvt_pk_bf16_f32 v85, v62, v63
    v_exp_f32 v66, v66
    v_exp_f32 v67, v67
    v_cvt_pk_bf16_f32 v86, v64, v65
    v_exp_f32 v68, v68
    v_exp_f32 v69, v69
    v_cvt_pk_bf16_f32 v87, v66, v67
    v_exp_f32 v70, v70
    v_mfma_f32_32x32x16_bf16 v[92:107], v[132:135], v[80:83], v[92:107]
    v_exp_f32 v71, v71
    v_cvt_pk_bf16_f32 v88, v68, v69
    v_exp_f32 v72, v72
    v_exp_f32 v73, v73
    v_cvt_pk_bf16_f32 v89, v70, v71
    v_exp_f32 v74, v74
    v_exp_f32 v75, v75
    v_cvt_pk_bf16_f32 v90, v72, v73
    v_cvt_pk_bf16_f32 v91, v74, v75
    v_cmp_gt_u32 vcc, v153, v149
    v_add_u32 v153, 1, v153
    s_cbranch_vccnz AT_slow3
AT_back3:
    v_mfma_f32_32x32x16_bf16 v[60:75], v[124:127], v[8:11], v[28:43]
    ds_read_b128 v[124:127], v144 offset:0
    s_mov_b64 exec, s[26:27]
    ds_read_b128 v[136:139], v145 offset:30720
    ds_read_b128 v[140:143], v145 offset:31232
    s_mov_b64 exec, -1
    ds_write_b32 v148, v151 offset:16
    s_cmp_eq_u32 s28, 0
    s_cbranch_scc0 AT_nodma3
    s_add_u32 m0, s23, 16384
    s_add_u32 s20, s20, 8192
    buffer_load_dwordx4 v146, s[12:15], s20 offen sc1 lds
    buffer_load_dwordx4 v146, s[12:15], s20 offen offset:1024 sc1 lds
AT_dmaback3:
    v_exp_f32 v44, v44
    v_exp_f32 v45, v45
    v_exp_f32 v46, v46
    v_exp_f32 v47, v47
    v_cvt_pk_bf16_f32 v76, v44, v45
    v_exp_f32 v48, v48
    v_mfma_f32_32x32x16_bf16 v[108:123], v[128:131], v[84:87], v[108:123]
    v_exp_f32 v49, v49
    v_cvt_pk_bf16_f32 v77, v46, v47
    v_exp_f32 v50, v50
    v_exp_f32 v51, v51
    v_cvt_pk_bf16_f32 v78, v48, v49
    v_exp_f32 v52, v52
    v_exp_f32 v53, v53
    v_cvt_pk_bf16_f32 v79, v50, v51
    v_exp_f32 v54, v54
    v_mfma_f32_32x32x16_bf16 v[108:123], v[132:135], v[88:91], v[108:123]
    v_exp_f32 v55, v55
    v_cvt_pk_bf16_f32 v80, v52, v53
    v_exp_f32 v56, v56
    v_exp_f32 v57, v57
    v_cvt_pk_bf16_f32 v81, v54, v55
    v_exp_f32 v58, v58
    v_exp_f32 v59, v59
    v_cvt_pk_bf16_f32 v82, v56, v57
    v_cvt_pk_bf16_f32 v83, v58, v59
    s_waitcnt lgkmcnt(0)
    v_mfma_f32_32x32x16_bf16 v[44:59], v[124:127], v[4:7], v[12:27]
    v_add_u32 v151, 1, v151
    v_exp_f32 v60, v60
    v_exp_f32 v61, v61
    v_exp_f32 v62, v62
    v_exp_f32 v63, v63
    v_cvt_pk_bf16_f32 v84, v60, v61
    v_exp_f32 v64, v64
    v_mfma_f32_32x32x16_bf16 v[92:107], v[136:139], v[76:79], v[92:107]
    v_exp_f32 v65, v65
    v_cvt_pk_bf16_f32 v85, v62, v63
    v_exp_f32 v66, v66
    v_exp_f32 v67, v67
    v_cvt_pk_bf16_f32 v86, v64, v65
    v_exp_f32 v68, v68
    v_exp_f32 v69, v69
    v_cvt_pk_bf16_f32 v87, v66, v67
    v_exp_f32 v70, v70
    v_mfma_f32_32x32x16_bf16 v[92:107], v[140:143], v[80:83], v[92:107]
    v_exp_f32 v71, v71
    v_cvt_pk_bf16_f32 v88, v68, v69
    v_exp_f32 v72, v72
    v_exp_f32 v73, v73
    v_cvt_pk_bf16_f32 v89, v70, v71
    v_exp_f32 v74, v74
    v_exp_f32 v75, v75
    v_cvt_pk_bf16_f32 v90, v72, v73
    v_cvt_pk_bf16_f32 v91, v74, v75
    s_add_u32 s28, s28, 1
    s_cmp_lt_u32 s28, 2
    s_cbranch_scc1 AT_loop
    v_mfma_f32_32x32x16_bf16 v[108:123], v[136:139], v[84:87], v[108:123]
    v_mfma_f32_32x32x16_bf16 v[108:123], v[140:143], v[88:91], v[108:123]
    s_lshl_b32 s37, s19, 2
    s_add_u32 s37, s37, 162896
    v_mov_b32 v150, s37
    v_mov_b32 v151, 1
    s_mov_b64 exec, 1
    ds_add_rtn_u32 v149, v150, v151
    s_mov_b64 exec, -1
    s_lshl_b32 s36, s19, 12
    s_add_u32 s37, s36, s34
    v_add_u32 v144, s37, v152
    s_xor_b32 s38, s33, 1
    s_lshl_b32 s38, s38, 15
    s_add_u32 s38, s38, s36
    v_add_u32 v145, s38, v152
    v_lshlrev_b32 v146, 3, v2
    s_lshl_b32 s37, s19, 9
    s_add_u32 s37, s37, 155648
    v_add_u32 v146, s37, v146
    s_waitcnt lgkmcnt(0)
    v_readfirstlane_b32 s37, v149
    v_mov_b32 v101, v116
    s_nop 3
    s_cmp_eq_u32 s37, 0
    s_cbranch_scc0 AT_last
AT_wfree:
    ds_read_b32 v149, v147
    s_waitcnt lgkmcnt(0)
    v_cmp_gt_u32 vcc, 6, v149
    s_nop 0
    s_and_b64 vcc, vcc, s[42:43]
    s_cbranch_vccnz AT_wfree
    ds_write_b128 v144, v[92:95] offset:0
    ds_write_b128 v144, v[96:99] offset:1024
    ds_write_b128 v144, v[108:111] offset:2048
    ds_write_b128 v144, v[112:115] offset:3072
    ds_write_b64 v146, v[100:101]
    ds_write_b32 v150, v151 offset:16
    s_load_dwordx2 s[24:25], s[0:1], 16
    s_load_dwordx2 s[26:27], s[0:1], 56
    s_load_dwordx2 s[28:29], s[0:1], 0
    s_lshr_b32 s53, s2, 3
    s_lshl_b32 s53, s53, 2
    s_add_u32 s53, s53, s19
    v_lshlrev_b32 v4, 7, v2
    s_lshl_b32 s20, s53, 13
    s_waitcnt lgkmcnt(0)
    s_mov_b32 s4, s26
    s_and_b32 s5, s27, 0xffff
    s_mov_b32 s6, 704512
    s_mov_b32 s7, 0x00020000
    buffer_load_dword v5, v4, s[4:7], s20 offen
    s_mov_b32 s8, s24
    s_and_b32 s9, s25, 0xffff
    s_mov_b32 s10, 524288
    s_mov_b32 s11, 0x00020000
    s_xor_b32 s20, s20, 0x80000
    buffer_load_dword v6, v4, s[8:11], s20 offen
    s_mov_b32 s4, s28
    s_and_b32 s5, s29, 0xffff
    s_mov_b32 s6, 2097152
    s_mov_b32 s7, 0x00020000
    s_and_b32 s20, s2, 7
    s_lshl_b32 s20, s20, 18
    s_lshl_b32 s53, s53, 11
    s_add_u32 s20, s20, s53
    s_mov_b64 exec, 0xffff
    buffer_load_dword v7, v4, s[4:7], s20 offen
    s_mov_b64 exec, -1
    s_endpgm
AT_last:
    ds_read_b32 v149, v150 offset:16
    s_waitcnt lgkmcnt(0)
    v_cmp_eq_u32 vcc, 0, v149
    s_nop 0
    s_cbranch_vccnz AT_last
    ds_read_b128 v[44:47], v145 offset:0
    ds_read_b128 v[48:51], v145 offset:1024
    ds_read_b128 v[60:63], v145 offset:2048
    ds_read_b128 v[64:67], v145 offset:3072
    ds_read_b64 v[52:53], v146
    s_mov_b32 s36, 0x7f800000
    s_mov_b32 s37, 0x0b800000
    s_waitcnt lgkmcnt(0)
    v_mov_b32 v68, v53
    s_mov_b64 s[38:39], 0
    v_add_f32 v92, v92, v44
    v_add_f32 v93, v93, v45
    v_add_f32 v94, v94, v46
    v_add_f32 v95, v95, v47
    v_add_f32 v96, v96, v48
    v_add_f32 v97, v97, v49
    v_add_f32 v98, v98, v50
    v_add_f32 v99, v99, v51
    v_add_f32 v100, v100, v52
    v_add_f32 v150, abs(v92), abs(v100)
    v_add_f32 v150, abs(v93), v150
    v_add_f32 v150, abs(v94), v150
    v_add_f32 v150, abs(v95), v150
    v_add_f32 v150, abs(v96), v150
    v_add_f32 v150, abs(v97), v150
    v_add_f32 v150, abs(v98), v150
    v_add_f32 v150, abs(v99), v150
    v_max3_f32 v149, abs(v92), abs(v93), abs(v94)
    v_max3_f32 v149, v149, abs(v95), abs(v96)
    v_max3_f32 v149, v149, abs(v97), abs(v98)
    v_max_f32 v149, v149, abs(v99)
    v_cmp_ngt_f32 vcc, s36, v150
    v_cmp_gt_f32 s[46:47], s37, v149
    s_or_b64 s[38:39], s[38:39], vcc
    s_nop 0
    s_or_b64 s[38:39], s[38:39], s[46:47]
    v_add_f32 v108, v108, v60
    v_add_f32 v109, v109, v61
    v_add_f32 v110, v110, v62
    v_add_f32 v111, v111, v63
    v_add_f32 v112, v112, v64
    v_add_f32 v113, v113, v65
    v_add_f32 v114, v114, v66
    v_add_f32 v115, v115, v67
    v_add_f32 v116, v116, v68
    v_add_f32 v150, abs(v108), abs(v116)
    v_add_f32 v150, abs(v109), v150
    v_add_f32 v150, abs(v110), v150
    v_add_f32 v150, abs(v111), v150
    v_add_f32 v150, abs(v112), v150
    v_add_f32 v150, abs(v113), v150
    v_add_f32 v150, abs(v114), v150
    v_add_f32 v150, abs(v115), v150
    v_max3_f32 v149, abs(v108), abs(v109), abs(v110)
    v_max3_f32 v149, v149, abs(v111), abs(v112)
    v_max3_f32 v149, v149, abs(v113), abs(v114)
    v_max_f32 v149, v149, abs(v115)
    v_cmp_ngt_f32 vcc, s36, v150
    v_cmp_gt_f32 s[46:47], s37, v149
    s_or_b64 s[38:39], s[38:39], vcc
    s_nop 0
    s_or_b64 s[38:39], s[38:39], s[46:47]
    s_cmp_lg_u64 s[38:39], 0
    s_cbranch_scc1 AT_redo
AT_fin:
    v_rcp_f32 v150, v100
    s_nop 0
    v_mul_f32 v92, v92, v150
    v_mul_f32 v93, v93, v150
    v_mul_f32 v94, v94, v150
    v_mul_f32 v95, v95, v150
    v_mul_f32 v96, v96, v150
    v_mul_f32 v97, v97, v150
    v_mul_f32 v98, v98, v150
    v_mul_f32 v99, v99, v150
    v_cvt_pk_bf16_f32 v76, v92, v93
    v_min_u32 v76, -2, v76
    v_cvt_pk_bf16_f32 v77, v94, v95
    v_min_u32 v77, -2, v77
    v_cvt_pk_bf16_f32 v78, v96, v97
    v_min_u32 v78, -2, v78
    v_cvt_pk_bf16_f32 v79, v98, v99
    v_min_u32 v79, -2, v79
    buffer_store_dwordx4 v[76:79], v152, s[12:15], s29 offen sc1
    s_add_u32 s29, s29, 76800
    v_rcp_f32 v150, v116
    s_nop 0
    v_mul_f32 v108, v108, v150
    v_mul_f32 v109, v109, v150
    v_mul_f32 v110, v110, v150
    v_mul_f32 v111, v111, v150
    v_mul_f32 v112, v112, v150
    v_mul_f32 v113, v113, v150
    v_mul_f32 v114, v114, v150
    v_mul_f32 v115, v115, v150
    v_cvt_pk_bf16_f32 v84, v108, v109
    v_min_u32 v84, -2, v84
    v_cvt_pk_bf16_f32 v85, v110, v111
    v_min_u32 v85, -2, v85
    v_cvt_pk_bf16_f32 v86, v112, v113
    v_min_u32 v86, -2, v86
    v_cvt_pk_bf16_f32 v87, v114, v115
    v_min_u32 v87, -2, v87
    buffer_store_dwordx4 v[84:87], v152, s[12:15], s29 offen sc1
    s_add_u32 s29, s29, 76800
    s_mov_b64 exec, 1
    v_mov_b32 v150, 1
    v_mov_b32 v151, 162956
    ds_add_u32 v151, v150
    s_mov_b64 exec, -1
    s_endpgm
AT_slow0:
    s_sleep 2
    ds_read_b32 v149, v147
    s_waitcnt lgkmcnt(0)
    v_add_u32 v149, 1, v149
    v_cmp_gt_u32 vcc, v153, v149
    s_nop 0
    s_cbranch_vccnz AT_slow0
    s_branch AT_back0
AT_slow1:
    s_sleep 2
    ds_read_b32 v149, v147
    s_waitcnt lgkmcnt(0)
    v_add_u32 v149, 1, v149
    v_cmp_gt_u32 vcc, v153, v149
    s_nop 0
    s_cbranch_vccnz AT_slow1
    s_branch AT_back1
AT_nodma1:
    s_waitcnt vmcnt(0)
    s_branch AT_dmaback1
AT_slow2:
    s_sleep 2
    ds_read_b32 v149, v147
    s_waitcnt lgkmcnt(0)
    v_add_u32 v149, 1, v149
    v_cmp_gt_u32 vcc, v153, v149
    s_nop 0
    s_cbranch_vccnz AT_slow2
    s_branch AT_back2
AT_nodma2:
    s_waitcnt vmcnt(0)
    s_branch AT_dmaback2
AT_slow3:
    s_sleep 2
    ds_read_b32 v149, v147
    s_waitcnt lgkmcnt(0)
    v_add_u32 v149, 1, v149
    v_cmp_gt_u32 vcc, v153, v149
    s_nop 0
    s_cbranch_vccnz AT_slow3
    s_branch AT_back3
AT_nodma3:
    s_waitcnt vmcnt(0)
    s_branch AT_dmaback3
AT_f1:
    v_mov_b32 v156, -1
    v_mov_b32 v157, -1
    v_mov_b32 v158, -1
    v_mov_b32 v159, -1
    s_add_u32 s36, s29, 76800
    buffer_store_dwordx4 v[156:159], v152, s[12:15], s29 offen sc1
    buffer_store_dwordx4 v[156:159], v152, s[12:15], s36 offen sc1
    s_branch AT_fback1
AT_f3:
    s_lshr_b32 s36, s21, 1
    s_lshl_b32 s36, s36, 8
    s_lshl_b32 s37, s17, 2
    s_add_u32 s36, s36, s37
    s_add_u32 s36, s36, 25198592
    s_mov_b64 exec, 1
    v_mov_b32 v154, 1
    v_mov_b32 v155, 0
    buffer_store_dword v154, v155, s[12:15], s36 offen sc1
    s_mov_b64 exec, -1
    s_branch AT_fback3
AT_redo:
    v_mov_b32 v150, 0xff800000
    v_mov_b32 v151, 0xff800000
    s_mov_b32 s20, s24
    s_mov_b32 s28, 0
AT_r1:
    buffer_load_dwordx4 v[124:127], v152, s[12:15], s20 offen sc1
    s_waitcnt vmcnt(0)
    v_mfma_f32_32x32x16_bf16 v[44:59], v[124:127], v[4:7], 0
    v_mfma_f32_32x32x16_bf16 v[60:75], v[124:127], v[8:11], 0
    s_add_u32 s20, s20, 2048
    s_add_u32 s28, s28, 1
    s_nop 11
    v_max3_f32 v150, v150, v44, v45
    v_max3_f32 v151, v151, v60, v61
    v_max3_f32 v150, v150, v46, v47
    v_max3_f32 v151, v151, v62, v63
    v_max3_f32 v150, v150, v48, v49
    v_max3_f32 v151, v151, v64, v65
    v_max3_f32 v150, v150, v50, v51
    v_max3_f32 v151, v151, v66, v67
    v_max3_f32 v150, v150, v52, v53
    v_max3_f32 v151, v151, v68, v69
    v_max3_f32 v150, v150, v54, v55
    v_max3_f32 v151, v151, v70, v71
    v_max3_f32 v150, v150, v56, v57
    v_max3_f32 v151, v151, v72, v73
    v_max3_f32 v150, v150, v58, v59
    v_max3_f32 v151, v151, v74, v75
    s_cmp_lt_u32 s28, 64
    s_cbranch_scc1 AT_r1
    v_mov_b32 v149, v150
    s_nop 1
    v_permlane32_swap_b32 v150, v149
    v_max_f32 v150, v150, v149
    v_sub_f32 v12, 0, v150
    v_mov_b32 v13, v12
    v_mov_b32 v14, v12
    v_mov_b32 v15, v12
    v_mov_b32 v16, v12
    v_mov_b32 v17, v12
    v_mov_b32 v18, v12
    v_mov_b32 v19, v12
    v_mov_b32 v20, v12
    v_mov_b32 v21, v12
    v_mov_b32 v22, v12
    v_mov_b32 v23, v12
    v_mov_b32 v24, v12
    v_mov_b32 v25, v12
    v_mov_b32 v26, v12
    v_mov_b32 v27, v12
    v_mov_b32 v149, v151
    s_nop 1
    v_permlane32_swap_b32 v151, v149
    v_max_f32 v151, v151, v149
    v_sub_f32 v28, 0, v151
    v_mov_b32 v29, v28
    v_mov_b32 v30, v28
    v_mov_b32 v31, v28
    v_mov_b32 v32, v28
    v_mov_b32 v33, v28
    v_mov_b32 v34, v28
    v_mov_b32 v35, v28
    v_mov_b32 v36, v28
    v_mov_b32 v37, v28
    v_mov_b32 v38, v28
    v_mov_b32 v39, v28
    v_mov_b32 v40, v28
    v_mov_b32 v41, v28
    v_mov_b32 v42, v28
    v_mov_b32 v43, v28
    v_mov_b32 v92, 0
    v_mov_b32 v93, 0
    v_mov_b32 v94, 0
    v_mov_b32 v95, 0
    v_mov_b32 v96, 0
    v_mov_b32 v97, 0
    v_mov_b32 v98, 0
    v_mov_b32 v99, 0
    v_mov_b32 v100, 0
    v_mov_b32 v101, 0
    v_mov_b32 v102, 0
    v_mov_b32 v103, 0
    v_mov_b32 v104, 0
    v_mov_b32 v105, 0
    v_mov_b32 v106, 0
    v_mov_b32 v107, 0
    v_mov_b32 v108, 0
    v_mov_b32 v109, 0
    v_mov_b32 v110, 0
    v_mov_b32 v111, 0
    v_mov_b32 v112, 0
    v_mov_b32 v113, 0
    v_mov_b32 v114, 0
    v_mov_b32 v115, 0
    v_mov_b32 v116, 0
    v_mov_b32 v117, 0
    v_mov_b32 v118, 0
    v_mov_b32 v119, 0
    v_mov_b32 v120, 0
    v_mov_b32 v121, 0
    v_mov_b32 v122, 0
    v_mov_b32 v123, 0
    v_and_b32 v145, 15, v2
    v_lshlrev_b32 v145, 4, v145
    v_lshrrev_b32 v150, 5, v2
    v_lshl_add_u32 v145, v150, 8, v145
    s_mov_b32 s20, s24
    s_mov_b32 s28, 0
AT_r2:
    buffer_load_dwordx4 v[124:127], v152, s[12:15], s20 offen sc1
    s_mov_b64 exec, s[26:27]
    buffer_load_dwordx4 v[128:131], v145, s[12:15], s20 offen offset:1024 sc1
    buffer_load_dwordx4 v[132:135], v145, s[12:15], s20 offen offset:1536 sc1
    s_mov_b64 exec, -1
    s_waitcnt vmcnt(0)
    v_mfma_f32_32x32x16_bf16 v[44:59], v[124:127], v[4:7], v[12:27]
    v_mfma_f32_32x32x16_bf16 v[60:75], v[124:127], v[8:11], v[28:43]
    s_add_u32 s20, s20, 2048
    s_add_u32 s28, s28, 1
    s_nop 11
    v_exp_f32 v44, v44
    v_exp_f32 v45, v45
    v_exp_f32 v46, v46
    v_exp_f32 v47, v47
    v_exp_f32 v48, v48
    v_exp_f32 v49, v49
    v_exp_f32 v50, v50
    v_exp_f32 v51, v51
    v_exp_f32 v52, v52
    v_exp_f32 v53, v53
    v_exp_f32 v54, v54
    v_exp_f32 v55, v55
    v_exp_f32 v56, v56
    v_exp_f32 v57, v57
    v_exp_f32 v58, v58
    v_exp_f32 v59, v59
    s_nop 0
    v_cvt_pk_bf16_f32 v76, v44, v45
    v_cvt_pk_bf16_f32 v77, v46, v47
    v_cvt_pk_bf16_f32 v78, v48, v49
    v_cvt_pk_bf16_f32 v79, v50, v51
    v_cvt_pk_bf16_f32 v80, v52, v53
    v_cvt_pk_bf16_f32 v81, v54, v55
    v_cvt_pk_bf16_f32 v82, v56, v57
    v_cvt_pk_bf16_f32 v83, v58, v59
    s_nop 1
    v_mfma_f32_32x32x16_bf16 v[92:107], v[128:131], v[76:79], v[92:107]
    v_mfma_f32_32x32x16_bf16 v[92:107], v[132:135], v[80:83], v[92:107]
    v_exp_f32 v60, v60
    v_exp_f32 v61, v61
    v_exp_f32 v62, v62
    v_exp_f32 v63, v63
    v_exp_f32 v64, v64
    v_exp_f32 v65, v65
    v_exp_f32 v66, v66
    v_exp_f32 v67, v67
    v_exp_f32 v68, v68
    v_exp_f32 v69, v69
    v_exp_f32 v70, v70
    v_exp_f32 v71, v71
    v_exp_f32 v72, v72
    v_exp_f32 v73, v73
    v_exp_f32 v74, v74
    v_exp_f32 v75, v75
    s_nop 0
    v_cvt_pk_bf16_f32 v84, v60, v61
    v_cvt_pk_bf16_f32 v85, v62, v63
    v_cvt_pk_bf16_f32 v86, v64, v65
    v_cvt_pk_bf16_f32 v87, v66, v67
    v_cvt_pk_bf16_f32 v88, v68, v69
    v_cvt_pk_bf16_f32 v89, v70, v71
    v_cvt_pk_bf16_f32 v90, v72, v73
    v_cvt_pk_bf16_f32 v91, v74, v75
    s_nop 1
    v_mfma_f32_32x32x16_bf16 v[108:123], v[128:131], v[84:87], v[108:123]
    v_mfma_f32_32x32x16_bf16 v[108:123], v[132:135], v[88:91], v[108:123]
    s_cmp_lt_u32 s28, 64
    s_cbranch_scc1 AT_r2
    s_nop 11
    s_branch AT_fin
M_gemm:
    s_add_u32 s16, s52, 8
    s_load_dwordx4 s[24:27], s[0:1], 40
    s_and_b32 s17, s2, 7
    s_lshl_b32 s17, s17, 2
    s_bfe_u32 s18, s2, 0x20003
    s_or_b32 s17, s17, s18
    s_lshr_b32 s18, s2, 5
    s_waitcnt lgkmcnt(0)
    s_mov_b32 s4, s24
    s_and_b32 s5, s25, 0xffff
    s_mov_b32 s6, 8388608
    s_mov_b32 s7, 0x00020000
    v_lshrrev_b32 v62, 4, v2
    v_and_b32 v11, 7, v2
    v_xor_b32 v62, v62, v11
    v_lshlrev_b32 v62, 4, v62
    v_lshrrev_b32 v11, 3, v2
    v_lshl_add_u32 v60, v11, 12, v62
    v_xor_b32 v61, 64, v60
    v_add_u32 v61, 32768, v61
    s_lshl_b32 s36, s17, 18
    s_lshl_b32 s20, s52, 10
    s_add_u32 s36, s36, s20
    s_lshl_b32 s21, s52, 14
    s_add_u32 s21, s21, 65536
    s_mov_b32 s22, s21
    s_mov_b32 s33, 0
    s_lshl_b32 s19, s33, 7
    s_add_u32 s19, s19, s36
    v_and_b32 v164, 3, v2
    v_lshlrev_b32 v164, 2, v164
    v_add_u32 v164, 162880, v164
    v_lshlrev_b32 v165, 2, v2
    v_add_u32 v165, 163072, v165
    s_lshl_b32 s28, s52, 2
    s_add_u32 s28, s28, 162880
    v_writelane_b32 v165, s28, 0
    s_mov_b32 s35, 0xffff0000
    s_mul_i32 s37, s18, 393216
    s_mul_i32 s29, s52, 98304
    s_add_u32 s37, s37, s29
    s_add_u32 s37, s37, 12582912
    s_mul_i32 s23, s33, 12288
    s_add_u32 s23, s23, s37
    v_lshlrev_b32 v62, 4, v2
    s_cmp_eq_u32 s18, 7
    s_cselect_b32 s28, 0x40000000, 0
    v_add_u32 v63, s28, v62
    v_and_b32 v13, 31, v2
    v_lshrrev_b32 v14, 5, v2
    v_bfe_u32 v3, v13, 1, 3
    v_xor_b32 v3, v3, v14
    v_lshlrev_b32 v3, 4, v3
    v_lshl_add_u32 v160, v13, 7, v3
    v_add_u32 v160, s21, v160
    v_xor_b32 v161, 32, v160
    v_xor_b32 v162, 64, v160
    v_xor_b32 v163, 96, v160
    v_mov_b32 v64, 0
    v_mov_b32 v65, 0
    v_mov_b32 v66, 0
    v_mov_b32 v67, 0
    v_mov_b32 v68, 0
    v_mov_b32 v69, 0
    v_mov_b32 v70, 0
    v_mov_b32 v71, 0
    v_mov_b32 v72, 0
    v_mov_b32 v73, 0
    v_mov_b32 v74, 0
    v_mov_b32 v75, 0
    v_mov_b32 v76, 0
    v_mov_b32 v77, 0
    v_mov_b32 v78, 0
    v_mov_b32 v79, 0
    v_mov_b32 v80, 0
    v_mov_b32 v81, 0
    v_mov_b32 v82, 0
    v_mov_b32 v83, 0
    v_mov_b32 v84, 0
    v_mov_b32 v85, 0
    v_mov_b32 v86, 0
    v_mov_b32 v87, 0
    v_mov_b32 v88, 0
    v_mov_b32 v89, 0
    v_mov_b32 v90, 0
    v_mov_b32 v91, 0
    v_mov_b32 v92, 0
    v_mov_b32 v93, 0
    v_mov_b32 v94, 0
    v_mov_b32 v95, 0
    v_mov_b32 v96, 0
    v_mov_b32 v97, 0
    v_mov_b32 v98, 0
    v_mov_b32 v99, 0
    v_mov_b32 v100, 0
    v_mov_b32 v101, 0
    v_mov_b32 v102, 0
    v_mov_b32 v103, 0
    v_mov_b32 v104, 0
    v_mov_b32 v105, 0
    v_mov_b32 v106, 0
    v_mov_b32 v107, 0
    v_mov_b32 v108, 0
    v_mov_b32 v109, 0
    v_mov_b32 v110, 0
    v_mov_b32 v111, 0
    v_mov_b32 v112, 0
    v_mov_b32 v113, 0
    v_mov_b32 v114, 0
    v_mov_b32 v115, 0
    v_mov_b32 v116, 0
    v_mov_b32 v117, 0
    v_mov_b32 v118, 0
    v_mov_b32 v119, 0
    v_mov_b32 v120, 0
    v_mov_b32 v121, 0
    v_mov_b32 v122, 0
    v_mov_b32 v123, 0
    v_mov_b32 v124, 0
    v_mov_b32 v125, 0
    v_mov_b32 v126, 0
    v_mov_b32 v127, 0
    v_mov_b32 v128, 0
    v_mov_b32 v129, 0
    v_mov_b32 v130, 0
    v_mov_b32 v131, 0
    v_mov_b32 v132, 0
    v_mov_b32 v133, 0
    v_mov_b32 v134, 0
    v_mov_b32 v135, 0
    v_mov_b32 v136, 0
    v_mov_b32 v137, 0
    v_mov_b32 v138, 0
    v_mov_b32 v139, 0
    v_mov_b32 v140, 0
    v_mov_b32 v141, 0
    v_mov_b32 v142, 0
    v_mov_b32 v143, 0
    v_mov_b32 v144, 0
    v_mov_b32 v145, 0
    v_mov_b32 v146, 0
    v_mov_b32 v147, 0
    v_mov_b32 v148, 0
    v_mov_b32 v149, 0
    v_mov_b32 v150, 0
    v_mov_b32 v151, 0
    v_mov_b32 v152, 0
    v_mov_b32 v153, 0
    v_mov_b32 v154, 0
    v_mov_b32 v155, 0
    v_mov_b32 v156, 0
    v_mov_b32 v157, 0
    v_mov_b32 v158, 0
    v_mov_b32 v159, 0
    s_cmp_eq_u32 s55, 1
    s_cbranch_scc0 G_noz
    v_mov_b32 v12, 162928
K1_w1:
    ds_read_b32 v13, v12
    s_waitcnt lgkmcnt(0)
    v_cmp_gt_u32 vcc, 1, v13
    s_nop 0
    s_cbranch_vccz K1_w1_ok
    s_sleep 2
    s_branch K1_w1
K1_w1_ok:
    v_mov_b32 v12, 162936
K1_w2:
    ds_read_b32 v13, v12
    s_waitcnt lgkmcnt(0)
    v_cmp_gt_u32 vcc, 8, v13
    s_nop 0
    s_cbranch_vccz K1_w2_ok
    s_sleep 2
    s_branch K1_w2
K1_w2_ok:
    ds_read_b64_tr_b16 v[44:45], v7 offset:0
    ds_read_b64_tr_b16 v[46:47], v7 offset:544
    ds_read_b64_tr_b16 v[48:49], v7 offset:2176
    ds_read_b64_tr_b16 v[50:51], v7 offset:2720
    ds_read_b64_tr_b16 v[52:53], v7 offset:64
    ds_read_b64_tr_b16 v[54:55], v7 offset:608
    ds_read_b64_tr_b16 v[56:57], v7 offset:2240
    ds_read_b64_tr_b16 v[58:59], v7 offset:2784
K1_poll:
    s_sleep 6
    s_mov_b32 s47, s42
    buffer_load_dwordx2 v[20:21], v6, s[12:15], s47 offen offset:0 sc1
    buffer_load_dwordx2 v[22:23], v6, s[12:15], s47 offen offset:2048 sc1
    s_add_u32 s47, s47, 4096
    buffer_load_dwordx2 v[24:25], v6, s[12:15], s47 offen offset:0 sc1
    buffer_load_dwordx2 v[26:27], v6, s[12:15], s47 offen offset:2048 sc1
    s_add_u32 s47, s47, 4096
    buffer_load_dwordx2 v[28:29], v6, s[12:15], s47 offen offset:0 sc1
    buffer_load_dwordx2 v[30:31], v6, s[12:15], s47 offen offset:2048 sc1
    s_add_u32 s47, s47, 4096
    buffer_load_dwordx2 v[32:33], v6, s[12:15], s47 offen offset:0 sc1
    buffer_load_dwordx2 v[34:35], v6, s[12:15], s47 offen offset:2048 sc1
    s_add_u32 s47, s47, 4096
    buffer_load_dwordx2 v[36:37], v6, s[12:15], s47 offen offset:0 sc1
    buffer_load_dwordx2 v[38:39], v6, s[12:15], s47 offen offset:2048 sc1
    s_add_u32 s47, s47, 4096
    buffer_load_dwordx2 v[40:41], v6, s[12:15], s47 offen offset:0 sc1
    s_waitcnt vmcnt(0)
    v_and_b32 v8, v21, v23
    v_bitop3_b32 v8, v8, v25, v27 bitop3:0x80
    v_bitop3_b32 v8, v8, v29, v31 bitop3:0x80
    v_bitop3_b32 v8, v8, v33, v35 bitop3:0x80
    v_bitop3_b32 v8, v8, v37, v39 bitop3:0x80
    v_and_b32 v8, v8, v41
    v_cmp_le_i32 vcc, 0, v8
    s_sub_u32 s63, s63, 1
    s_cbranch_scc1 K1_pollx
    s_cbranch_vccnz K1_poll
K1_pollx:
    v_pk_add_f32 v[20:21], v[20:21], v[22:23]
    v_pk_add_f32 v[20:21], v[20:21], v[24:25]
    v_pk_add_f32 v[20:21], v[20:21], v[26:27]
    v_pk_add_f32 v[20:21], v[20:21], v[28:29]
    v_pk_add_f32 v[20:21], v[20:21], v[30:31]
    v_pk_add_f32 v[20:21], v[20:21], v[32:33]
    v_pk_add_f32 v[20:21], v[20:21], v[34:35]
    v_pk_add_f32 v[20:21], v[20:21], v[36:37]
    v_pk_add_f32 v[20:21], v[20:21], v[38:39]
    v_pk_add_f32 v[20:21], v[20:21], v[40:41]
    v_mov_b32 v22, v20
    v_mov_b32 v23, v21
    s_nop 1
    v_permlane32_swap_b32 v20, v22
    v_permlane32_swap_b32 v21, v23
    v_add_f32 v20, v20, v22
    v_sub_f32 v21, 0, v21
    v_sub_f32 v21, v21, v23
    v_mul_f32 v24, 0x3abe82fa, v20
    v_mul_f32 v26, 0x3abe82fa, v21
    v_fma_f32 v26, -v24, v24, v26
    v_max_f32 v26, 0, v26
    v_cvt_pk_bf16_f32 v26, v26, v26
    v_and_b32 v26, 0xffff0000, v26
    v_add_f32 v26, 0x3727c5ac, v26
    v_cvt_pk_bf16_f32 v26, v26, v26
    v_and_b32 v26, 0xffff0000, v26
    v_sqrt_f32 v26, v26
    s_nop 0
    v_cvt_pk_bf16_f32 v26, v26, v26
    v_and_b32 v26, 0xffff0000, v26
    v_rcp_f32 v25, v26
    v_cvt_pk_bf16_f32 v24, v24, v24
    v_and_b32 v24, 0xffff0000, v24
    v_mul_f32 v24, v24, v25
    ds_write_b32 v17, v24
    ds_write_b32 v17, v25 offset:512
    ds_read_b128 v[12:15], v9 offset:0
    ds_read_b128 v[28:31], v9 offset:512
    ds_read_b128 v[16:19], v9 offset:16
    ds_read_b128 v[32:35], v9 offset:528
    ds_read_b128 v[20:23], v9 offset:64
    ds_read_b128 v[36:39], v9 offset:576
    ds_read_b128 v[24:27], v9 offset:80
    ds_read_b128 v[40:43], v9 offset:592
    s_waitcnt lgkmcnt(0)
    v_lshlrev_b32 v4, 16, v44
    v_and_b32 v5, s35, v44
    v_pk_fma_f32 v[4:5], v[4:5], v[28:29], v[12:13] neg_lo:[0,0,1] neg_hi:[0,0,1]
    v_cvt_pk_bf16_f32 v44, v4, v5
    v_lshlrev_b32 v4, 16, v45
    v_and_b32 v5, s35, v45
    v_pk_fma_f32 v[4:5], v[4:5], v[30:31], v[14:15] neg_lo:[0,0,1] neg_hi:[0,0,1]
    v_cvt_pk_bf16_f32 v45, v4, v5
    v_lshlrev_b32 v4, 16, v46
    v_and_b32 v5, s35, v46
    v_pk_fma_f32 v[4:5], v[4:5], v[32:33], v[16:17] neg_lo:[0,0,1] neg_hi:[0,0,1]
    v_cvt_pk_bf16_f32 v46, v4, v5
    v_lshlrev_b32 v4, 16, v47
    v_and_b32 v5, s35, v47
    v_pk_fma_f32 v[4:5], v[4:5], v[34:35], v[18:19] neg_lo:[0,0,1] neg_hi:[0,0,1]
    v_cvt_pk_bf16_f32 v47, v4, v5
    buffer_store_dwordx4 v[44:47], v62, s[12:15], s40 offen offset:0 sc1
    v_lshlrev_b32 v4, 16, v48
    v_and_b32 v5, s35, v48
    v_pk_fma_f32 v[4:5], v[4:5], v[36:37], v[20:21] neg_lo:[0,0,1] neg_hi:[0,0,1]
    v_cvt_pk_bf16_f32 v48, v4, v5
    v_lshlrev_b32 v4, 16, v49
    v_and_b32 v5, s35, v49
    v_pk_fma_f32 v[4:5], v[4:5], v[38:39], v[22:23] neg_lo:[0,0,1] neg_hi:[0,0,1]
    v_cvt_pk_bf16_f32 v49, v4, v5
    v_lshlrev_b32 v4, 16, v50
    v_and_b32 v5, s35, v50
    v_pk_fma_f32 v[4:5], v[4:5], v[40:41], v[24:25] neg_lo:[0,0,1] neg_hi:[0,0,1]
    v_cvt_pk_bf16_f32 v50, v4, v5
    v_lshlrev_b32 v4, 16, v51
    v_and_b32 v5, s35, v51
    v_pk_fma_f32 v[4:5], v[4:5], v[42:43], v[26:27] neg_lo:[0,0,1] neg_hi:[0,0,1]
    v_cvt_pk_bf16_f32 v51, v4, v5
    buffer_store_dwordx4 v[48:51], v62, s[12:15], s40 offen offset:3072 sc1
    v_lshlrev_b32 v4, 16, v52
    v_and_b32 v5, s35, v52
    v_pk_fma_f32 v[4:5], v[4:5], v[28:29], v[12:13] neg_lo:[0,0,1] neg_hi:[0,0,1]
    v_cvt_pk_bf16_f32 v52, v4, v5
    v_lshlrev_b32 v4, 16, v53
    v_and_b32 v5, s35, v53
    v_pk_fma_f32 v[4:5], v[4:5], v[30:31], v[14:15] neg_lo:[0,0,1] neg_hi:[0,0,1]
    v_cvt_pk_bf16_f32 v53, v4, v5
    v_lshlrev_b32 v4, 16, v54
    v_and_b32 v5, s35, v54
    v_pk_fma_f32 v[4:5], v[4:5], v[32:33], v[16:17] neg_lo:[0,0,1] neg_hi:[0,0,1]
    v_cvt_pk_bf16_f32 v54, v4, v5
    v_lshlrev_b32 v4, 16, v55
    v_and_b32 v5, s35, v55
    v_pk_fma_f32 v[4:5], v[4:5], v[34:35], v[18:19] neg_lo:[0,0,1] neg_hi:[0,0,1]
    v_cvt_pk_bf16_f32 v55, v4, v5
    buffer_store_dwordx4 v[52:55], v62, s[12:15], s41 offen offset:0 sc1
    v_lshlrev_b32 v4, 16, v56
    v_and_b32 v5, s35, v56
    v_pk_fma_f32 v[4:5], v[4:5], v[36:37], v[20:21] neg_lo:[0,0,1] neg_hi:[0,0,1]
    v_cvt_pk_bf16_f32 v56, v4, v5
    v_lshlrev_b32 v4, 16, v57
    v_and_b32 v5, s35, v57
    v_pk_fma_f32 v[4:5], v[4:5], v[38:39], v[22:23] neg_lo:[0,0,1] neg_hi:[0,0,1]
    v_cvt_pk_bf16_f32 v57, v4, v5
    v_lshlrev_b32 v4, 16, v58
    v_and_b32 v5, s35, v58
    v_pk_fma_f32 v[4:5], v[4:5], v[40:41], v[24:25] neg_lo:[0,0,1] neg_hi:[0,0,1]
    v_cvt_pk_bf16_f32 v58, v4, v5
    v_lshlrev_b32 v4, 16, v59
    v_and_b32 v5, s35, v59
    v_pk_fma_f32 v[4:5], v[4:5], v[42:43], v[26:27] neg_lo:[0,0,1] neg_hi:[0,0,1]
    v_cvt_pk_bf16_f32 v59, v4, v5
    buffer_store_dwordx4 v[56:59], v62, s[12:15], s41 offen offset:3072 sc1
    s_waitcnt vmcnt(0)
    s_mov_b64 exec, 1
    v_mov_b32 v20, 162940
    v_mov_b32 v21, 1
    ds_add_rtn_u32 v20, v20, v21
    v_mov_b32 v22, 0
    s_waitcnt lgkmcnt(0)
    v_cmp_eq_u32 vcc, 11, v20
    s_nop 0
    s_cbranch_vccz K1_az
    s_mov_b64 exec, 0xff
    v_lshlrev_b32 v22, 11, v2
    v_mov_b32 v21, 1
    buffer_store_dword v21, v22, s[12:15], s43 offen sc1
K1_az:
    s_mov_b64 exec, -1
G_noz:
    v_and_b32 v3, 11, v2
    v_lshlrev_b32 v3, 2, v3
    v_add_u32 v3, 162816, v3
G_hold:
    s_sleep 8
    ds_read_b32 v4, v3
    s_waitcnt lgkmcnt(0)
    v_cmp_eq_u32 vcc, 0, v4
    s_nop 0
    s_cbranch_vccnz G_hold
    s_add_u32 m0, s22, 0
    s_add_u32 s28, s19, 0
    buffer_load_dwordx4 v60, s[4:7], s28 offen lds
    s_add_u32 m0, s22, 1024
    s_nop 0
    buffer_load_dwordx4 v61, s[4:7], s28 offen lds
    s_add_u32 m0, s22, 2048
    s_add_u32 s28, s19, 65536
    buffer_load_dwordx4 v60, s[4:7], s28 offen lds
    s_add_u32 m0, s22, 3072
    s_nop 0
    buffer_load_dwordx4 v61, s[4:7], s28 offen lds
    s_add_u32 m0, s22, 4096
    s_add_u32 s28, s19, 131072
    buffer_load_dwordx4 v60, s[4:7], s28 offen lds
    s_add_u32 m0, s22, 5120
    s_nop 0
    buffer_load_dwordx4 v61, s[4:7], s28 offen lds
    s_add_u32 m0, s22, 6144
    s_add_u32 s28, s19, 196608
    buffer_load_dwordx4 v60, s[4:7], s28 offen lds
    s_add_u32 m0, s22, 7168
    s_nop 0
    buffer_load_dwordx4 v61, s[4:7], s28 offen lds
    s_xor_b32 s22, s22, 8192
    s_cmp_eq_u32 s52, 0
    s_cbranch_scc0 G_wg
    s_mul_i32 s28, s18, 6
    s_max_u32 s28, s28, 1
    s_sub_u32 s28, s28, 1
    s_lshr_b32 s28, s28, 2
    v_lshrrev_b32 v3, 4, v2
    v_min_u32 v3, 2, v3
    v_add_u32 v3, s28, v3
    v_min_u32 v3, 10, v3
    v_lshlrev_b32 v3, 7, v3
    v_and_b32 v4, 15, v2
    v_lshl_add_u32 v3, v4, 2, v3
    s_lshr_b32 s28, s17, 2
    s_lshl_b32 s28, s28, 11
    s_add_u32 s28, s28, 25182208
    v_add_u32 v3, s28, v3
    v_mov_b32 v4, 162928
G_wr:
    ds_read_b32 v5, v4
    s_waitcnt lgkmcnt(0)
    v_cmp_gt_u32 vcc, 1, v5
    s_nop 0
    s_cbranch_vccz G_wr_ok
    s_sleep 2
    s_branch G_wr
G_wr_ok:
G_poll:
    buffer_load_dword v4, v3, s[12:15], 0 offen sc1
    s_waitcnt vmcnt(0)
    v_cmp_ne_u32 vcc, 1, v4
    s_nop 0
    s_cbranch_vccz G_poll_ok
    s_sleep 16
    s_sub_u32 s63, s63, 1
    s_cbranch_scc0 G_poll
G_poll_ok:
    v_mov_b32 v3, 162948
    v_mov_b32 v4, 1
    ds_write_b32 v3, v4
    s_branch G_go
G_wg:
    v_mov_b32 v3, 162948
G_ww:
    ds_read_b32 v4, v3
    s_waitcnt lgkmcnt(0)
    v_cmp_gt_u32 vcc, 1, v4
    s_nop 0
    s_cbranch_vccz G_ww_ok
    s_sleep 8
    s_branch G_ww
G_ww_ok:
G_go:
    s_lshr_b32 s38, s52, 1
    s_lshl_b32 s39, s17, 1
    s_add_u32 s38, s38, s39
    s_and_b32 s39, s52, 1
    s_mul_i32 s39, s39, 3
    s_mul_i32 s40, s18, 6
    s_add_u32 s39, s39, s40
    s_sub_u32 s39, s39, 1
    s_mul_i32 s40, s38, 75
    s_add_u32 s40, s40, s39
    s_add_u32 s40, s40, 32
    s_lshl_b32 s40, s40, 10
    s_add_u32 s40, s40, 16777216
    s_lshl_b32 s41, s17, 8
    s_lshl_b32 s42, s18, 2
    s_add_u32 s41, s41, s42
    s_add_u32 s41, s41, 25198720
    v_mov_b32 v8, -1
    v_mov_b32 v9, -1
    v_mov_b32 v10, -1
    v_mov_b32 v11, -1
    s_add_u32 s42, s39, 0
    s_cmp_ge_u32 s42, 43
    s_cbranch_scc1 G_nf0
    buffer_store_dwordx4 v[8:11], v62, s[12:15], s40 offen offset:0 sc1
G_nf0:
    s_add_u32 s42, s39, 1
    s_cmp_ge_u32 s42, 43
    s_cbranch_scc1 G_nf1
    buffer_store_dwordx4 v[8:11], v62, s[12:15], s40 offen offset:1024 sc1
G_nf1:
    s_add_u32 s42, s39, 2
    s_cmp_ge_u32 s42, 43
    s_cbranch_scc1 G_nf2
    buffer_store_dwordx4 v[8:11], v62, s[12:15], s40 offen offset:2048 sc1
G_nf2:
    buffer_load_dwordx4 v[16:19], v62, s[12:15], s23 offen offset:0 sc1
    buffer_load_dwordx4 v[20:23], v63, s[12:15], s23 offen offset:1024 sc1
    buffer_load_dwordx4 v[24:27], v63, s[12:15], s23 offen offset:2048 sc1
    s_add_u32 s23, s23, 3072
    buffer_load_dwordx4 v[28:31], v62, s[12:15], s23 offen offset:0 sc1
    buffer_load_dwordx4 v[32:35], v63, s[12:15], s23 offen offset:1024 sc1
    buffer_load_dwordx4 v[36:39], v63, s[12:15], s23 offen offset:2048 sc1
    s_add_u32 s23, s23, 3072
    s_mov_b32 s29, 0
    s_setprio 0
G2_loop:
    s_waitcnt vmcnt(3)
    ds_read_b128 v[4:7], v160
    ds_read_b128 v[8:11], v160 offset:4096
    buffer_load_dwordx4 v[40:43], v62, s[12:15], s23 offen offset:0 sc1
    buffer_load_dwordx4 v[44:47], v63, s[12:15], s23 offen offset:1024 sc1
    buffer_load_dwordx4 v[48:51], v63, s[12:15], s23 offen offset:2048 sc1
    s_add_u32 s23, s23, 3072
    s_add_u32 s33, s33, 1
    s_and_b32 s33, s33, 7
    s_lshl_b32 s19, s33, 7
    s_add_u32 s19, s19, s36
    s_mul_i32 s34, s33, 12288
    s_add_u32 s34, s34, s37
    s_cmp_eq_u32 s29, 7
    s_cmov_b32 s19, 0x40000000
    s_cmov_b32 s34, 0x20000000
    ds_read_b128 v[52:55], v161
    ds_read_b128 v[56:59], v161 offset:4096
    s_waitcnt lgkmcnt(2)
    v_mfma_f32_32x32x16_bf16 v[64:79], v[16:19], v[4:7], v[64:79]
    v_mfma_f32_32x32x16_bf16 v[80:95], v[20:23], v[4:7], v[80:95]
    v_mfma_f32_32x32x16_bf16 v[96:111], v[24:27], v[4:7], v[96:111]
    v_mfma_f32_32x32x16_bf16 v[112:127], v[16:19], v[8:11], v[112:127]
    v_mfma_f32_32x32x16_bf16 v[128:143], v[20:23], v[8:11], v[128:143]
    v_mfma_f32_32x32x16_bf16 v[144:159], v[24:27], v[8:11], v[144:159]
    s_add_u32 m0, s22, 0
    s_add_u32 s28, s19, 0
    buffer_load_dwordx4 v60, s[4:7], s28 offen lds
    s_add_u32 m0, s22, 1024
    s_nop 0
    buffer_load_dwordx4 v61, s[4:7], s28 offen lds
    s_add_u32 m0, s22, 2048
    s_add_u32 s28, s19, 65536
    buffer_load_dwordx4 v60, s[4:7], s28 offen lds
    s_add_u32 m0, s22, 3072
    s_nop 0
    buffer_load_dwordx4 v61, s[4:7], s28 offen lds
    s_add_u32 m0, s22, 4096
    s_add_u32 s28, s19, 131072
    buffer_load_dwordx4 v60, s[4:7], s28 offen lds
    s_add_u32 m0, s22, 5120
    s_nop 0
    buffer_load_dwordx4 v61, s[4:7], s28 offen lds
    s_add_u32 m0, s22, 6144
    s_add_u32 s28, s19, 196608
    buffer_load_dwordx4 v60, s[4:7], s28 offen lds
    s_add_u32 m0, s22, 7168
    s_nop 0
    buffer_load_dwordx4 v61, s[4:7], s28 offen lds
    s_xor_b32 s22, s22, 8192
    buffer_load_dwordx4 v[16:19], v62, s[12:15], s23 offen offset:0 sc1
    buffer_load_dwordx4 v[20:23], v63, s[12:15], s23 offen offset:1024 sc1
    buffer_load_dwordx4 v[24:27], v63, s[12:15], s23 offen offset:2048 sc1
    s_add_u32 s23, s23, 3072
    s_waitcnt vmcnt(14)
    ds_read_b128 v[4:7], v162
    ds_read_b128 v[8:11], v162 offset:4096
    s_waitcnt lgkmcnt(2)
    v_mfma_f32_32x32x16_bf16 v[64:79], v[28:31], v[52:55], v[64:79]
    v_mfma_f32_32x32x16_bf16 v[80:95], v[32:35], v[52:55], v[80:95]
    v_mfma_f32_32x32x16_bf16 v[96:111], v[36:39], v[52:55], v[96:111]
    v_mfma_f32_32x32x16_bf16 v[112:127], v[28:31], v[56:59], v[112:127]
    v_mfma_f32_32x32x16_bf16 v[128:143], v[32:35], v[56:59], v[128:143]
    v_mfma_f32_32x32x16_bf16 v[144:159], v[36:39], v[56:59], v[144:159]
    s_mov_b32 s23, s34
    buffer_load_dwordx4 v[28:31], v62, s[12:15], s23 offen offset:0 sc1
    buffer_load_dwordx4 v[32:35], v63, s[12:15], s23 offen offset:1024 sc1
    buffer_load_dwordx4 v[36:39], v63, s[12:15], s23 offen offset:2048 sc1
    s_add_u32 s23, s23, 3072
    s_waitcnt vmcnt(14)
    ds_read_b128 v[52:55], v163
    ds_read_b128 v[56:59], v163 offset:4096
    s_waitcnt lgkmcnt(2)
    v_mfma_f32_32x32x16_bf16 v[64:79], v[40:43], v[4:7], v[64:79]
    v_mfma_f32_32x32x16_bf16 v[80:95], v[44:47], v[4:7], v[80:95]
    v_mfma_f32_32x32x16_bf16 v[96:111], v[48:51], v[4:7], v[96:111]
    v_mfma_f32_32x32x16_bf16 v[112:127], v[40:43], v[8:11], v[112:127]
    v_mfma_f32_32x32x16_bf16 v[128:143], v[44:47], v[8:11], v[128:143]
    v_mfma_f32_32x32x16_bf16 v[144:159], v[48:51], v[8:11], v[144:159]
    buffer_load_dwordx4 v[40:43], v62, s[12:15], s23 offen offset:0 sc1
    buffer_load_dwordx4 v[44:47], v63, s[12:15], s23 offen offset:1024 sc1
    buffer_load_dwordx4 v[48:51], v63, s[12:15], s23 offen offset:2048 sc1
    s_add_u32 s23, s23, 3072
    s_waitcnt vmcnt(6)
    s_waitcnt lgkmcnt(0)
    v_mfma_f32_32x32x16_bf16 v[64:79], v[16:19], v[52:55], v[64:79]
    v_mfma_f32_32x32x16_bf16 v[80:95], v[20:23], v[52:55], v[80:95]
    v_mfma_f32_32x32x16_bf16 v[96:111], v[24:27], v[52:55], v[96:111]
    v_mfma_f32_32x32x16_bf16 v[112:127], v[16:19], v[56:59], v[112:127]
    v_mfma_f32_32x32x16_bf16 v[128:143], v[20:23], v[56:59], v[128:143]
    v_mfma_f32_32x32x16_bf16 v[144:159], v[24:27], v[56:59], v[144:159]
    v_xor_b32 v160, 8192, v160
    v_xor_b32 v161, 8192, v161
    v_xor_b32 v162, 8192, v162
    v_xor_b32 v163, 8192, v163
    s_add_u32 s29, s29, 1
    s_cmp_ge_u32 s29, 8
    s_cbranch_scc1 G2_done
    s_waitcnt vmcnt(3)
    ds_read_b128 v[4:7], v160
    ds_read_b128 v[8:11], v160 offset:4096
    buffer_load_dwordx4 v[16:19], v62, s[12:15], s23 offen offset:0 sc1
    buffer_load_dwordx4 v[20:23], v63, s[12:15], s23 offen offset:1024 sc1
    buffer_load_dwordx4 v[24:27], v63, s[12:15], s23 offen offset:2048 sc1
    s_add_u32 s23, s23, 3072
    s_add_u32 s33, s33, 1
    s_and_b32 s33, s33, 7
    s_lshl_b32 s19, s33, 7
    s_add_u32 s19, s19, s36
    s_mul_i32 s34, s33, 12288
    s_add_u32 s34, s34, s37
    s_cmp_eq_u32 s29, 7
    s_cmov_b32 s19, 0x40000000
    s_cmov_b32 s34, 0x20000000
    ds_read_b128 v[52:55], v161
    ds_read_b128 v[56:59], v161 offset:4096
    s_waitcnt lgkmcnt(2)
    v_mfma_f32_32x32x16_bf16 v[64:79], v[28:31], v[4:7], v[64:79]
    v_mfma_f32_32x32x16_bf16 v[80:95], v[32:35], v[4:7], v[80:95]
    v_mfma_f32_32x32x16_bf16 v[96:111], v[36:39], v[4:7], v[96:111]
    v_mfma_f32_32x32x16_bf16 v[112:127], v[28:31], v[8:11], v[112:127]
    v_mfma_f32_32x32x16_bf16 v[128:143], v[32:35], v[8:11], v[128:143]
    v_mfma_f32_32x32x16_bf16 v[144:159], v[36:39], v[8:11], v[144:159]
    s_add_u32 m0, s22, 0
    s_add_u32 s28, s19, 0
    buffer_load_dwordx4 v60, s[4:7], s28 offen lds
    s_add_u32 m0, s22, 1024
    s_nop 0
    buffer_load_dwordx4 v61, s[4:7], s28 offen lds
    s_add_u32 m0, s22, 2048
    s_add_u32 s28, s19, 65536
    buffer_load_dwordx4 v60, s[4:7], s28 offen lds
    s_add_u32 m0, s22, 3072
    s_nop 0
    buffer_load_dwordx4 v61, s[4:7], s28 offen lds
    s_add_u32 m0, s22, 4096
    s_add_u32 s28, s19, 131072
    buffer_load_dwordx4 v60, s[4:7], s28 offen lds
    s_add_u32 m0, s22, 5120
    s_nop 0
    buffer_load_dwordx4 v61, s[4:7], s28 offen lds
    s_add_u32 m0, s22, 6144
    s_add_u32 s28, s19, 196608
    buffer_load_dwordx4 v60, s[4:7], s28 offen lds
    s_add_u32 m0, s22, 7168
    s_nop 0
    buffer_load_dwordx4 v61, s[4:7], s28 offen lds
    s_xor_b32 s22, s22, 8192
    buffer_load_dwordx4 v[28:31], v62, s[12:15], s23 offen offset:0 sc1
    buffer_load_dwordx4 v[32:35], v63, s[12:15], s23 offen offset:1024 sc1
    buffer_load_dwordx4 v[36:39], v63, s[12:15], s23 offen offset:2048 sc1
    s_add_u32 s23, s23, 3072
    s_waitcnt vmcnt(14)
    ds_read_b128 v[4:7], v162
    ds_read_b128 v[8:11], v162 offset:4096
    s_waitcnt lgkmcnt(2)
    v_mfma_f32_32x32x16_bf16 v[64:79], v[40:43], v[52:55], v[64:79]
    v_mfma_f32_32x32x16_bf16 v[80:95], v[44:47], v[52:55], v[80:95]
    v_mfma_f32_32x32x16_bf16 v[96:111], v[48:51], v[52:55], v[96:111]
    v_mfma_f32_32x32x16_bf16 v[112:127], v[40:43], v[56:59], v[112:127]
    v_mfma_f32_32x32x16_bf16 v[128:143], v[44:47], v[56:59], v[128:143]
    v_mfma_f32_32x32x16_bf16 v[144:159], v[48:51], v[56:59], v[144:159]
    s_mov_b32 s23, s34
    buffer_load_dwordx4 v[40:43], v62, s[12:15], s23 offen offset:0 sc1
    buffer_load_dwordx4 v[44:47], v63, s[12:15], s23 offen offset:1024 sc1
    buffer_load_dwordx4 v[48:51], v63, s[12:15], s23 offen offset:2048 sc1
    s_add_u32 s23, s23, 3072
    s_waitcnt vmcnt(14)
    ds_read_b128 v[52:55], v163
    ds_read_b128 v[56:59], v163 offset:4096
    s_waitcnt lgkmcnt(2)
    v_mfma_f32_32x32x16_bf16 v[64:79], v[16:19], v[4:7], v[64:79]
    v_mfma_f32_32x32x16_bf16 v[80:95], v[20:23], v[4:7], v[80:95]
    v_mfma_f32_32x32x16_bf16 v[96:111], v[24:27], v[4:7], v[96:111]
    v_mfma_f32_32x32x16_bf16 v[112:127], v[16:19], v[8:11], v[112:127]
    v_mfma_f32_32x32x16_bf16 v[128:143], v[20:23], v[8:11], v[128:143]
    v_mfma_f32_32x32x16_bf16 v[144:159], v[24:27], v[8:11], v[144:159]
    buffer_load_dwordx4 v[16:19], v62, s[12:15], s23 offen offset:0 sc1
    buffer_load_dwordx4 v[20:23], v63, s[12:15], s23 offen offset:1024 sc1
    buffer_load_dwordx4 v[24:27], v63, s[12:15], s23 offen offset:2048 sc1
    s_add_u32 s23, s23, 3072
    s_waitcnt vmcnt(6)
    s_waitcnt lgkmcnt(0)
    v_mfma_f32_32x32x16_bf16 v[64:79], v[28:31], v[52:55], v[64:79]
    v_mfma_f32_32x32x16_bf16 v[80:95], v[32:35], v[52:55], v[80:95]
    v_mfma_f32_32x32x16_bf16 v[96:111], v[36:39], v[52:55], v[96:111]
    v_mfma_f32_32x32x16_bf16 v[112:127], v[28:31], v[56:59], v[112:127]
    v_mfma_f32_32x32x16_bf16 v[128:143], v[32:35], v[56:59], v[128:143]
    v_mfma_f32_32x32x16_bf16 v[144:159], v[36:39], v[56:59], v[144:159]
    v_xor_b32 v160, 8192, v160
    v_xor_b32 v161, 8192, v161
    v_xor_b32 v162, 8192, v162
    v_xor_b32 v163, 8192, v163
    s_add_u32 s29, s29, 1
    s_cmp_ge_u32 s29, 8
    s_cbranch_scc1 G2_done
    s_waitcnt vmcnt(3)
    ds_read_b128 v[4:7], v160
    ds_read_b128 v[8:11], v160 offset:4096
    buffer_load_dwordx4 v[28:31], v62, s[12:15], s23 offen offset:0 sc1
    buffer_load_dwordx4 v[32:35], v63, s[12:15], s23 offen offset:1024 sc1
    buffer_load_dwordx4 v[36:39], v63, s[12:15], s23 offen offset:2048 sc1
    s_add_u32 s23, s23, 3072
    s_add_u32 s33, s33, 1
    s_and_b32 s33, s33, 7
    s_lshl_b32 s19, s33, 7
    s_add_u32 s19, s19, s36
    s_mul_i32 s34, s33, 12288
    s_add_u32 s34, s34, s37
    s_cmp_eq_u32 s29, 7
    s_cmov_b32 s19, 0x40000000
    s_cmov_b32 s34, 0x20000000
    ds_read_b128 v[52:55], v161
    ds_read_b128 v[56:59], v161 offset:4096
    s_waitcnt lgkmcnt(2)
    v_mfma_f32_32x32x16_bf16 v[64:79], v[40:43], v[4:7], v[64:79]
    v_mfma_f32_32x32x16_bf16 v[80:95], v[44:47], v[4:7], v[80:95]
    v_mfma_f32_32x32x16_bf16 v[96:111], v[48:51], v[4:7], v[96:111]
    v_mfma_f32_32x32x16_bf16 v[112:127], v[40:43], v[8:11], v[112:127]
    v_mfma_f32_32x32x16_bf16 v[128:143], v[44:47], v[8:11], v[128:143]
    v_mfma_f32_32x32x16_bf16 v[144:159], v[48:51], v[8:11], v[144:159]
    s_add_u32 m0, s22, 0
    s_add_u32 s28, s19, 0
    buffer_load_dwordx4 v60, s[4:7], s28 offen lds
    s_add_u32 m0, s22, 1024
    s_nop 0
    buffer_load_dwordx4 v61, s[4:7], s28 offen lds
    s_add_u32 m0, s22, 2048
    s_add_u32 s28, s19, 65536
    buffer_load_dwordx4 v60, s[4:7], s28 offen lds
    s_add_u32 m0, s22, 3072
    s_nop 0
    buffer_load_dwordx4 v61, s[4:7], s28 offen lds
    s_add_u32 m0, s22, 4096
    s_add_u32 s28, s19, 131072
    buffer_load_dwordx4 v60, s[4:7], s28 offen lds
    s_add_u32 m0, s22, 5120
    s_nop 0
    buffer_load_dwordx4 v61, s[4:7], s28 offen lds
    s_add_u32 m0, s22, 6144
    s_add_u32 s28, s19, 196608
    buffer_load_dwordx4 v60, s[4:7], s28 offen lds
    s_add_u32 m0, s22, 7168
    s_nop 0
    buffer_load_dwordx4 v61, s[4:7], s28 offen lds
    s_xor_b32 s22, s22, 8192
    buffer_load_dwordx4 v[40:43], v62, s[12:15], s23 offen offset:0 sc1
    buffer_load_dwordx4 v[44:47], v63, s[12:15], s23 offen offset:1024 sc1
    buffer_load_dwordx4 v[48:51], v63, s[12:15], s23 offen offset:2048 sc1
    s_add_u32 s23, s23, 3072
    s_waitcnt vmcnt(14)
    ds_read_b128 v[4:7], v162
    ds_read_b128 v[8:11], v162 offset:4096
    s_waitcnt lgkmcnt(2)
    v_mfma_f32_32x32x16_bf16 v[64:79], v[16:19], v[52:55], v[64:79]
    v_mfma_f32_32x32x16_bf16 v[80:95], v[20:23], v[52:55], v[80:95]
    v_mfma_f32_32x32x16_bf16 v[96:111], v[24:27], v[52:55], v[96:111]
    v_mfma_f32_32x32x16_bf16 v[112:127], v[16:19], v[56:59], v[112:127]
    v_mfma_f32_32x32x16_bf16 v[128:143], v[20:23], v[56:59], v[128:143]
    v_mfma_f32_32x32x16_bf16 v[144:159], v[24:27], v[56:59], v[144:159]
    s_mov_b32 s23, s34
    buffer_load_dwordx4 v[16:19], v62, s[12:15], s23 offen offset:0 sc1
    buffer_load_dwordx4 v[20:23], v63, s[12:15], s23 offen offset:1024 sc1
    buffer_load_dwordx4 v[24:27], v63, s[12:15], s23 offen offset:2048 sc1
    s_add_u32 s23, s23, 3072
    s_waitcnt vmcnt(14)
    ds_read_b128 v[52:55], v163
    ds_read_b128 v[56:59], v163 offset:4096
    s_waitcnt lgkmcnt(2)
    v_mfma_f32_32x32x16_bf16 v[64:79], v[28:31], v[4:7], v[64:79]
    v_mfma_f32_32x32x16_bf16 v[80:95], v[32:35], v[4:7], v[80:95]
    v_mfma_f32_32x32x16_bf16 v[96:111], v[36:39], v[4:7], v[96:111]
    v_mfma_f32_32x32x16_bf16 v[112:127], v[28:31], v[8:11], v[112:127]
    v_mfma_f32_32x32x16_bf16 v[128:143], v[32:35], v[8:11], v[128:143]
    v_mfma_f32_32x32x16_bf16 v[144:159], v[36:39], v[8:11], v[144:159]
    buffer_load_dwordx4 v[28:31], v62, s[12:15], s23 offen offset:0 sc1
    buffer_load_dwordx4 v[32:35], v63, s[12:15], s23 offen offset:1024 sc1
    buffer_load_dwordx4 v[36:39], v63, s[12:15], s23 offen offset:2048 sc1
    s_add_u32 s23, s23, 3072
    s_waitcnt vmcnt(6)
    s_waitcnt lgkmcnt(0)
    v_mfma_f32_32x32x16_bf16 v[64:79], v[40:43], v[52:55], v[64:79]
    v_mfma_f32_32x32x16_bf16 v[80:95], v[44:47], v[52:55], v[80:95]
    v_mfma_f32_32x32x16_bf16 v[96:111], v[48:51], v[52:55], v[96:111]
    v_mfma_f32_32x32x16_bf16 v[112:127], v[40:43], v[56:59], v[112:127]
    v_mfma_f32_32x32x16_bf16 v[128:143], v[44:47], v[56:59], v[128:143]
    v_mfma_f32_32x32x16_bf16 v[144:159], v[48:51], v[56:59], v[144:159]
    s_setprio 3
    s_cmp_eq_u32 s29, 2
    s_cbranch_scc0 G_chk
    s_mov_b64 exec, 1
    v_mov_b32 v12, 162968
    v_mov_b32 v13, 1
    ds_add_rtn_u32 v12, v12, v13
    v_mov_b32 v14, 0
    s_waitcnt lgkmcnt(0)
    v_cmp_eq_u32 vcc, 3, v12
    s_nop 0
    s_cbranch_vccz G_a2
    buffer_store_dword v13, v14, s[12:15], s41 offen sc1
G_a2:
    s_mov_b64 exec, -1
G_chkback:
    v_xor_b32 v160, 8192, v160
    v_xor_b32 v161, 8192, v161
    v_xor_b32 v162, 8192, v162
    v_xor_b32 v163, 8192, v163
    s_setprio 0
    s_add_u32 s29, s29, 1
    s_cmp_ge_u32 s29, 8
    s_cbranch_scc1 G2_done
    s_branch G2_loop
G_chk:
    s_cmp_eq_u32 s52, 0
    s_cbranch_scc0 G_chkback
    v_min_u32 v12, 39, v2
    s_lshl_b32 s28, s17, 8
    s_add_u32 s28, s28, 25198592
    v_lshl_add_u32 v12, v12, 2, s28
G_p2:
    buffer_load_dword v13, v12, s[12:15], 0 offen sc1
    s_waitcnt vmcnt(0)
    v_cmp_ne_u32 vcc, 1, v13
    s_nop 0
    s_cbranch_vccz G_p2_ok
    s_sleep 8
    s_sub_u32 s63, s63, 1
    s_cbranch_scc0 G_p2
G_p2_ok:
    v_mov_b32 v12, 162960
    v_mov_b32 v13, 1
    ds_write_b32 v12, v13
    s_branch G_chkback
G2_done:
    s_setprio 1
    s_mov_b32 s20, s38
    s_mov_b32 s22, s39
    s_mul_i32 s23, s20, 43
    s_add_u32 s23, s23, s22
    s_lshl_b32 s23, s23, 10
    s_add_u32 s23, s23, 6291456
    s_waitcnt vmcnt(0)
    buffer_load_dwordx4 v[16:19], v62, s[12:15], s23 offen offset:0 sc1
    buffer_load_dwordx4 v[20:23], v62, s[12:15], s23 offen offset:1024 sc1
    buffer_load_dwordx4 v[24:27], v62, s[12:15], s23 offen offset:2048 sc1
    s_mov_b32 s28, s40
    s_lshl_b32 s20, s20, 6
    v_and_b32 v3, 31, v2
    v_lshlrev_b32 v3, 1, v3
    s_mov_b32 s8, s26
    s_and_b32 s9, s27, 0xffff
    s_mov_b32 s10, 4096
    s_mov_b32 s11, 0x00020000
    buffer_load_ushort v28, v3, s[8:11], s20 offen
    v_mov_b32 v167, 1
    ds_write_b32 v165, v167
G_sync1:
    ds_read_b32 v166, v164
    s_waitcnt lgkmcnt(0)
    v_cmp_gt_u32 vcc, 1, v166
    s_nop 0
    s_cbranch_vccz G_synced1
    s_sleep 1
    s_branch G_sync1
G_synced1:
    s_cmp_eq_u32 s52, 0
    s_cbranch_scc1 G_skipw0
    s_sub_u32 s19, s52, 1
    s_and_b32 s19, s19, 3
    s_mul_i32 s19, s19, 6144
    s_add_u32 s19, s19, 65536
    v_add_u32 v4, s19, v62
    ds_write_b128 v4, v[64:67] offset:0
    ds_write_b128 v4, v[68:71] offset:1024
    ds_write_b128 v4, v[72:75] offset:2048
    ds_write_b128 v4, v[76:79] offset:3072
    ds_write_b128 v4, v[80:83] offset:4096
    ds_write_b128 v4, v[84:87] offset:5120
    s_branch G_donew0
G_skipw0:
    v_pk_mov_b32 v[32:33], v[64:65], v[64:65] op_sel:[0,1]
    v_pk_mov_b32 v[34:35], v[66:67], v[66:67] op_sel:[0,1]
    v_pk_mov_b32 v[36:37], v[68:69], v[68:69] op_sel:[0,1]
    v_pk_mov_b32 v[38:39], v[70:71], v[70:71] op_sel:[0,1]
    v_pk_mov_b32 v[40:41], v[72:73], v[72:73] op_sel:[0,1]
    v_pk_mov_b32 v[42:43], v[74:75], v[74:75] op_sel:[0,1]
    v_pk_mov_b32 v[44:45], v[76:77], v[76:77] op_sel:[0,1]
    v_pk_mov_b32 v[46:47], v[78:79], v[78:79] op_sel:[0,1]
    v_pk_mov_b32 v[48:49], v[80:81], v[80:81] op_sel:[0,1]
    v_pk_mov_b32 v[50:51], v[82:83], v[82:83] op_sel:[0,1]
    v_pk_mov_b32 v[52:53], v[84:85], v[84:85] op_sel:[0,1]
    v_pk_mov_b32 v[54:55], v[86:87], v[86:87] op_sel:[0,1]
G_donew0:
    s_cmp_eq_u32 s52, 1
    s_cbranch_scc1 G_skipw1
    s_sub_u32 s19, s52, 2
    s_and_b32 s19, s19, 3
    s_mul_i32 s19, s19, 6144
    s_add_u32 s19, s19, 83968
    v_add_u32 v4, s19, v62
    ds_write_b128 v4, v[88:91] offset:0
    ds_write_b128 v4, v[92:95] offset:1024
    ds_write_b128 v4, v[96:99] offset:2048
    ds_write_b128 v4, v[100:103] offset:3072
    ds_write_b128 v4, v[104:107] offset:4096
    ds_write_b128 v4, v[108:111] offset:5120
    s_branch G_donew1
G_skipw1:
    v_pk_mov_b32 v[32:33], v[88:89], v[88:89] op_sel:[0,1]
    v_pk_mov_b32 v[34:35], v[90:91], v[90:91] op_sel:[0,1]
    v_pk_mov_b32 v[36:37], v[92:93], v[92:93] op_sel:[0,1]
    v_pk_mov_b32 v[38:39], v[94:95], v[94:95] op_sel:[0,1]
    v_pk_mov_b32 v[40:41], v[96:97], v[96:97] op_sel:[0,1]
    v_pk_mov_b32 v[42:43], v[98:99], v[98:99] op_sel:[0,1]
    v_pk_mov_b32 v[44:45], v[100:101], v[100:101] op_sel:[0,1]
    v_pk_mov_b32 v[46:47], v[102:103], v[102:103] op_sel:[0,1]
    v_pk_mov_b32 v[48:49], v[104:105], v[104:105] op_sel:[0,1]
    v_pk_mov_b32 v[50:51], v[106:107], v[106:107] op_sel:[0,1]
    v_pk_mov_b32 v[52:53], v[108:109], v[108:109] op_sel:[0,1]
    v_pk_mov_b32 v[54:55], v[110:111], v[110:111] op_sel:[0,1]
G_donew1:
    s_cmp_eq_u32 s52, 2
    s_cbranch_scc1 G_skipw2
    s_sub_u32 s19, s52, 3
    s_and_b32 s19, s19, 3
    s_mul_i32 s19, s19, 6144
    s_add_u32 s19, s19, 102400
    v_add_u32 v4, s19, v62
    ds_write_b128 v4, v[112:115] offset:0
    ds_write_b128 v4, v[116:119] offset:1024
    ds_write_b128 v4, v[120:123] offset:2048
    ds_write_b128 v4, v[124:127] offset:3072
    ds_write_b128 v4, v[128:131] offset:4096
    ds_write_b128 v4, v[132:135] offset:5120
    s_branch G_donew2
G_skipw2:
    v_pk_mov_b32 v[32:33], v[112:113], v[112:113] op_sel:[0,1]
    v_pk_mov_b32 v[34:35], v[114:115], v[114:115] op_sel:[0,1]
    v_pk_mov_b32 v[36:37], v[116:117], v[116:117] op_sel:[0,1]
    v_pk_mov_b32 v[38:39], v[118:119], v[118:119] op_sel:[0,1]
    v_pk_mov_b32 v[40:41], v[120:121], v[120:121] op_sel:[0,1]
    v_pk_mov_b32 v[42:43], v[122:123], v[122:123] op_sel:[0,1]
    v_pk_mov_b32 v[44:45], v[124:125], v[124:125] op_sel:[0,1]
    v_pk_mov_b32 v[46:47], v[126:127], v[126:127] op_sel:[0,1]
    v_pk_mov_b32 v[48:49], v[128:129], v[128:129] op_sel:[0,1]
    v_pk_mov_b32 v[50:51], v[130:131], v[130:131] op_sel:[0,1]
    v_pk_mov_b32 v[52:53], v[132:133], v[132:133] op_sel:[0,1]
    v_pk_mov_b32 v[54:55], v[134:135], v[134:135] op_sel:[0,1]
G_donew2:
    s_cmp_eq_u32 s52, 3
    s_cbranch_scc1 G_skipw3
    s_sub_u32 s19, s52, 4
    s_and_b32 s19, s19, 3
    s_mul_i32 s19, s19, 6144
    s_add_u32 s19, s19, 120832
    v_add_u32 v4, s19, v62
    ds_write_b128 v4, v[136:139] offset:0
    ds_write_b128 v4, v[140:143] offset:1024
    ds_write_b128 v4, v[144:147] offset:2048
    ds_write_b128 v4, v[148:151] offset:3072
    ds_write_b128 v4, v[152:155] offset:4096
    ds_write_b128 v4, v[156:159] offset:5120
    s_branch G_donew3
G_skipw3:
    v_pk_mov_b32 v[32:33], v[136:137], v[136:137] op_sel:[0,1]
    v_pk_mov_b32 v[34:35], v[138:139], v[138:139] op_sel:[0,1]
    v_pk_mov_b32 v[36:37], v[140:141], v[140:141] op_sel:[0,1]
    v_pk_mov_b32 v[38:39], v[142:143], v[142:143] op_sel:[0,1]
    v_pk_mov_b32 v[40:41], v[144:145], v[144:145] op_sel:[0,1]
    v_pk_mov_b32 v[42:43], v[146:147], v[146:147] op_sel:[0,1]
    v_pk_mov_b32 v[44:45], v[148:149], v[148:149] op_sel:[0,1]
    v_pk_mov_b32 v[46:47], v[150:151], v[150:151] op_sel:[0,1]
    v_pk_mov_b32 v[48:49], v[152:153], v[152:153] op_sel:[0,1]
    v_pk_mov_b32 v[50:51], v[154:155], v[154:155] op_sel:[0,1]
    v_pk_mov_b32 v[52:53], v[156:157], v[156:157] op_sel:[0,1]
    v_pk_mov_b32 v[54:55], v[158:159], v[158:159] op_sel:[0,1]
G_donew3:
    s_mul_i32 s19, s52, 18432
    s_add_u32 s19, s19, 65536
    v_add_u32 v5, s19, v62
    v_mov_b32 v167, 2
    ds_write_b32 v165, v167
G_sync2:
    ds_read_b32 v166, v164
    s_waitcnt lgkmcnt(0)
    v_cmp_gt_u32 vcc, 2, v166
    s_nop 0
    s_cbranch_vccz G_synced2
    s_sleep 1
    s_branch G_sync2
G_synced2:
    ds_read_b128 v[64:67], v5 offset:0
    ds_read_b128 v[68:71], v5 offset:1024
    ds_read_b128 v[72:75], v5 offset:2048
    ds_read_b128 v[76:79], v5 offset:3072
    ds_read_b128 v[80:83], v5 offset:4096
    ds_read_b128 v[84:87], v5 offset:5120
    ds_read_b128 v[88:91], v5 offset:6144
    ds_read_b128 v[92:95], v5 offset:7168
    ds_read_b128 v[96:99], v5 offset:8192
    ds_read_b128 v[100:103], v5 offset:9216
    ds_read_b128 v[104:107], v5 offset:10240
    ds_read_b128 v[108:111], v5 offset:11264
    ds_read_b128 v[112:115], v5 offset:12288
    ds_read_b128 v[116:119], v5 offset:13312
    ds_read_b128 v[120:123], v5 offset:14336
    ds_read_b128 v[124:127], v5 offset:15360
    ds_read_b128 v[128:131], v5 offset:16384
    ds_read_b128 v[132:135], v5 offset:17408
    s_waitcnt vmcnt(0)
    v_lshlrev_b32 v28, 16, v28
    v_pk_add_f32 v[32:33], v[32:33], v[28:29] op_sel_hi:[1,0]
    v_pk_add_f32 v[34:35], v[34:35], v[28:29] op_sel_hi:[1,0]
    v_pk_add_f32 v[36:37], v[36:37], v[28:29] op_sel_hi:[1,0]
    v_pk_add_f32 v[38:39], v[38:39], v[28:29] op_sel_hi:[1,0]
    v_pk_add_f32 v[40:41], v[40:41], v[28:29] op_sel_hi:[1,0]
    v_pk_add_f32 v[42:43], v[42:43], v[28:29] op_sel_hi:[1,0]
    v_pk_add_f32 v[44:45], v[44:45], v[28:29] op_sel_hi:[1,0]
    v_pk_add_f32 v[46:47], v[46:47], v[28:29] op_sel_hi:[1,0]
    v_pk_add_f32 v[48:49], v[48:49], v[28:29] op_sel_hi:[1,0]
    v_pk_add_f32 v[50:51], v[50:51], v[28:29] op_sel_hi:[1,0]
    v_pk_add_f32 v[52:53], v[52:53], v[28:29] op_sel_hi:[1,0]
    v_pk_add_f32 v[54:55], v[54:55], v[28:29] op_sel_hi:[1,0]
    s_waitcnt lgkmcnt(12)
    v_pk_add_f32 v[32:33], v[32:33], v[64:65]
    v_pk_add_f32 v[34:35], v[34:35], v[66:67]
    v_pk_add_f32 v[36:37], v[36:37], v[68:69]
    v_pk_add_f32 v[38:39], v[38:39], v[70:71]
    v_pk_add_f32 v[40:41], v[40:41], v[72:73]
    v_pk_add_f32 v[42:43], v[42:43], v[74:75]
    v_pk_add_f32 v[44:45], v[44:45], v[76:77]
    v_pk_add_f32 v[46:47], v[46:47], v[78:79]
    v_pk_add_f32 v[48:49], v[48:49], v[80:81]
    v_pk_add_f32 v[50:51], v[50:51], v[82:83]
    v_pk_add_f32 v[52:53], v[52:53], v[84:85]
    v_pk_add_f32 v[54:55], v[54:55], v[86:87]
    s_waitcnt lgkmcnt(6)
    v_pk_add_f32 v[32:33], v[32:33], v[88:89]
    v_pk_add_f32 v[34:35], v[34:35], v[90:91]
    v_pk_add_f32 v[36:37], v[36:37], v[92:93]
    v_pk_add_f32 v[38:39], v[38:39], v[94:95]
    v_pk_add_f32 v[40:41], v[40:41], v[96:97]
    v_pk_add_f32 v[42:43], v[42:43], v[98:99]
    v_pk_add_f32 v[44:45], v[44:45], v[100:101]
    v_pk_add_f32 v[46:47], v[46:47], v[102:103]
    v_pk_add_f32 v[48:49], v[48:49], v[104:105]
    v_pk_add_f32 v[50:51], v[50:51], v[106:107]
    v_pk_add_f32 v[52:53], v[52:53], v[108:109]
    v_pk_add_f32 v[54:55], v[54:55], v[110:111]
    s_waitcnt lgkmcnt(0)
    v_pk_add_f32 v[32:33], v[32:33], v[112:113]
    v_pk_add_f32 v[34:35], v[34:35], v[114:115]
    v_pk_add_f32 v[36:37], v[36:37], v[116:117]
    v_pk_add_f32 v[38:39], v[38:39], v[118:119]
    v_pk_add_f32 v[40:41], v[40:41], v[120:121]
    v_pk_add_f32 v[42:43], v[42:43], v[122:123]
    v_pk_add_f32 v[44:45], v[44:45], v[124:125]
    v_pk_add_f32 v[46:47], v[46:47], v[126:127]
    v_pk_add_f32 v[48:49], v[48:49], v[128:129]
    v_pk_add_f32 v[50:51], v[50:51], v[130:131]
    v_pk_add_f32 v[52:53], v[52:53], v[132:133]
    v_pk_add_f32 v[54:55], v[54:55], v[134:135]
    v_lshlrev_b32 v4, 16, v16
    v_and_b32 v5, s35, v16
    v_pk_mul_f32 v[4:5], v[4:5], v[32:33]
    v_cvt_pk_bf16_f32 v16, v4, v5
    v_min_u32 v16, -2, v16
    v_lshlrev_b32 v4, 16, v17
    v_and_b32 v5, s35, v17
    v_pk_mul_f32 v[4:5], v[4:5], v[34:35]
    v_cvt_pk_bf16_f32 v17, v4, v5
    v_min_u32 v17, -2, v17
    v_lshlrev_b32 v4, 16, v18
    v_and_b32 v5, s35, v18
    v_pk_mul_f32 v[4:5], v[4:5], v[36:37]
    v_cvt_pk_bf16_f32 v18, v4, v5
    v_min_u32 v18, -2, v18
    v_lshlrev_b32 v4, 16, v19
    v_and_b32 v5, s35, v19
    v_pk_mul_f32 v[4:5], v[4:5], v[38:39]
    v_cvt_pk_bf16_f32 v19, v4, v5
    v_min_u32 v19, -2, v19
    s_add_u32 s20, s22, 0
    s_cmp_ge_u32 s20, 43
    s_cbranch_scc1 G2_sk0
    buffer_store_dwordx4 v[16:19], v62, s[12:15], s28 offen offset:0 sc1
G2_sk0:
    v_lshlrev_b32 v4, 16, v20
    v_and_b32 v5, s35, v20
    v_pk_mul_f32 v[4:5], v[4:5], v[40:41]
    v_cvt_pk_bf16_f32 v20, v4, v5
    v_min_u32 v20, -2, v20
    v_lshlrev_b32 v4, 16, v21
    v_and_b32 v5, s35, v21
    v_pk_mul_f32 v[4:5], v[4:5], v[42:43]
    v_cvt_pk_bf16_f32 v21, v4, v5
    v_min_u32 v21, -2, v21
    v_lshlrev_b32 v4, 16, v22
    v_and_b32 v5, s35, v22
    v_pk_mul_f32 v[4:5], v[4:5], v[44:45]
    v_cvt_pk_bf16_f32 v22, v4, v5
    v_min_u32 v22, -2, v22
    v_lshlrev_b32 v4, 16, v23
    v_and_b32 v5, s35, v23
    v_pk_mul_f32 v[4:5], v[4:5], v[46:47]
    v_cvt_pk_bf16_f32 v23, v4, v5
    v_min_u32 v23, -2, v23
    s_add_u32 s20, s22, 1
    s_cmp_ge_u32 s20, 43
    s_cbranch_scc1 G2_sk1
    buffer_store_dwordx4 v[20:23], v62, s[12:15], s28 offen offset:1024 sc1
G2_sk1:
    v_lshlrev_b32 v4, 16, v24
    v_and_b32 v5, s35, v24
    v_pk_mul_f32 v[4:5], v[4:5], v[48:49]
    v_cvt_pk_bf16_f32 v24, v4, v5
    v_min_u32 v24, -2, v24
    v_lshlrev_b32 v4, 16, v25
    v_and_b32 v5, s35, v25
    v_pk_mul_f32 v[4:5], v[4:5], v[50:51]
    v_cvt_pk_bf16_f32 v25, v4, v5
    v_min_u32 v25, -2, v25
    v_lshlrev_b32 v4, 16, v26
    v_and_b32 v5, s35, v26
    v_pk_mul_f32 v[4:5], v[4:5], v[52:53]
    v_cvt_pk_bf16_f32 v26, v4, v5
    v_min_u32 v26, -2, v26
    v_lshlrev_b32 v4, 16, v27
    v_and_b32 v5, s35, v27
    v_pk_mul_f32 v[4:5], v[4:5], v[54:55]
    v_cvt_pk_bf16_f32 v27, v4, v5
    v_min_u32 v27, -2, v27
    s_add_u32 s20, s22, 2
    s_cmp_ge_u32 s20, 43
    s_cbranch_scc1 G2_sk2
    buffer_store_dwordx4 v[24:27], v62, s[12:15], s28 offen offset:2048 sc1
G2_sk2:
G2_skip:
    s_load_dwordx2 s[24:25], s[0:1], 16
    s_load_dwordx4 s[36:39], s[0:1], 56
    s_load_dwordx2 s[28:29], s[0:1], 0
    s_mov_b64 exec, 1
    v_mov_b32 v4, 162952
    v_mov_b32 v5, 1
    ds_add_u32 v4, v5
    s_mov_b64 exec, -1
    v_bfe_u32 v3, v2, 4, 1
    v_lshlrev_b32 v3, 2, v3
    v_and_b32 v4, 7, v2
    v_xor_b32 v3, v3, v4
    v_lshlrev_b32 v3, 4, v3
    v_lshrrev_b32 v4, 3, v2
    v_lshl_add_u32 v3, v4, 10, v3
    s_lshl_b32 s19, s18, 7
    v_add_u32 v3, s19, v3
    v_add_u32 v4, 8192-1024, v3
    v_lshlrev_b32 v5, 4, v2
    v_add_u32 v6, 76800, v5
    s_lshl_b32 s20, s52, 17
    s_mul_i32 s21, s52, 180224
    s_mul_i32 s22, s17, 153600
    s_lshl_b32 s23, s52, 13
    s_add_u32 s23, s23, s22
    s_mul_i32 s26, s52, 11264
    s_add_u32 s26, s26, s22
    s_add_u32 s26, s26, 32768
    s_mul_i32 s27, s52, 22528
    s_add_u32 s27, s27, 65536
    v_lshrrev_b32 v7, 5, v2
    v_bfe_u32 v160, v2, 2, 2
    v_lshl_add_u32 v161, v7, 2, v160
    v_lshlrev_b32 v161, 7, v161
    v_bfe_u32 v162, v2, 4, 1
    v_lshlrev_b32 v162, 1, v162
    v_bfe_u32 v163, v2, 1, 1
    v_add_u32 v162, v162, v163
    v_lshrrev_b32 v160, 1, v160
    v_lshlrev_b32 v160, 2, v160
    v_xor_b32 v162, v162, v160
    v_lshl_add_u32 v161, v162, 4, v161
    v_and_b32 v163, 1, v2
    v_lshl_add_u32 v161, v163, 3, v161
    v_add_u32 v161, s27, v161
    v_xor_b32 v162, 64, v161
    v_and_b32 v160, 31, v2
    s_lshl_b32 s32, s17, 6
    s_lshr_b32 s33, s52, 1
    s_lshl_b32 s33, s33, 5
    s_add_u32 s32, s32, s33
    s_lshl_b32 s32, s32, 10
    s_and_b32 s33, s52, 1
    s_lshl_b32 s33, s33, 6
    s_add_u32 s32, s32, s33
    s_add_u32 s32, s32, s19
    v_lshlrev_b32 v160, 10, v160
    v_lshl_add_u32 v160, v7, 4, v160
    s_waitcnt lgkmcnt(0)
    s_mov_b32 s4, s24
    s_and_b32 s5, s25, 0xffff
    s_mov_b32 s6, 524288
    s_mov_b32 s7, 0x00020000
    s_mov_b32 s8, s36
    s_and_b32 s9, s37, 0xffff
    s_mov_b32 s10, 704512
    s_mov_b32 s11, 0x00020000
    s_mov_b32 s40, s28
    s_and_b32 s41, s29, 0xffff
    s_mov_b32 s42, 2097152
    s_mov_b32 s43, 0x00020000
    s_mov_b32 s44, s38
    s_and_b32 s45, s39, 0xffff
    s_mov_b32 s46, 2097152
    s_mov_b32 s47, 0x00020000
    s_add_u32 s36, s50, 16777216
    s_addc_u32 s37, s51, 0
    s_and_b32 s37, s37, 0xffff
    s_mov_b32 s38, 4915200
    s_mov_b32 s39, 0x00020000
    v_mov_b32 v8, 162952
C_w1:
    ds_read_b32 v9, v8
    s_waitcnt lgkmcnt(0)
    v_cmp_gt_u32 vcc, 4, v9
    s_nop 0
    s_cbranch_vccz C_w1_ok
    s_sleep 2
    s_branch C_w1
C_w1_ok:
    s_add_u32 m0, s27, 0
    s_nop 0
    buffer_load_dwordx4 v3, s[8:11], s21 offen lds
    buffer_load_dwordx4 v4, s[8:11], s21 offen offset:1024 lds
    s_add_u32 s21, s21, 16384
    s_add_u32 m0, s27, 2048
    s_nop 0
    buffer_load_dwordx4 v3, s[8:11], s21 offen lds
    buffer_load_dwordx4 v4, s[8:11], s21 offen offset:1024 lds
    s_add_u32 s21, s21, 16384
    s_add_u32 m0, s27, 4096
    s_nop 0
    buffer_load_dwordx4 v3, s[8:11], s21 offen lds
    buffer_load_dwordx4 v4, s[8:11], s21 offen offset:1024 lds
    s_add_u32 s21, s21, 16384
    s_add_u32 m0, s27, 6144
    s_nop 0
    buffer_load_dwordx4 v3, s[8:11], s21 offen lds
    buffer_load_dwordx4 v4, s[8:11], s21 offen offset:1024 lds
    s_add_u32 s21, s21, 16384
    s_add_u32 m0, s27, 8192
    s_nop 0
    buffer_load_dwordx4 v3, s[8:11], s21 offen lds
    buffer_load_dwordx4 v4, s[8:11], s21 offen offset:1024 lds
    s_add_u32 s21, s21, 16384
    s_add_u32 m0, s27, 10240
    s_nop 0
    buffer_load_dwordx4 v3, s[8:11], s21 offen lds
    buffer_load_dwordx4 v4, s[8:11], s21 offen offset:1024 lds
    s_add_u32 s21, s21, 16384
    s_add_u32 m0, s27, 12288
    s_nop 0
    buffer_load_dwordx4 v3, s[8:11], s21 offen lds
    buffer_load_dwordx4 v4, s[8:11], s21 offen offset:1024 lds
    s_add_u32 s21, s21, 16384
    s_add_u32 m0, s27, 14336
    s_nop 0
    buffer_load_dwordx4 v3, s[8:11], s21 offen lds
    buffer_load_dwordx4 v4, s[8:11], s21 offen offset:1024 lds
    s_add_u32 s21, s21, 16384
    s_add_u32 m0, s27, 16384
    s_nop 0
    buffer_load_dwordx4 v3, s[8:11], s21 offen lds
    buffer_load_dwordx4 v4, s[8:11], s21 offen offset:1024 lds
    s_add_u32 s21, s21, 16384
    s_add_u32 m0, s27, 18432
    s_nop 0
    buffer_load_dwordx4 v3, s[8:11], s21 offen lds
    buffer_load_dwordx4 v4, s[8:11], s21 offen offset:1024 lds
    s_add_u32 s21, s21, 16384
    s_add_u32 m0, s27, 20480
    s_nop 0
    buffer_load_dwordx4 v3, s[8:11], s21 offen lds
    buffer_load_dwordx4 v4, s[8:11], s21 offen offset:1024 lds
    s_add_u32 s21, s21, 16384
    buffer_load_dwordx4 v[88:91], v160, s[40:43], s32 offen offset:0
    buffer_load_dwordx4 v[92:95], v160, s[40:43], s32 offen offset:32
    v_mov_b32 v8, 162960
C_ww:
    ds_read_b32 v9, v8
    s_waitcnt lgkmcnt(0)
    v_cmp_gt_u32 vcc, 1, v9
    s_nop 0
    s_cbranch_vccz C_ww_ok
    s_sleep 2
    s_branch C_ww
C_ww_ok:
    s_setprio 0
    s_add_u32 s28, s26, 0
    buffer_load_dwordx4 v[24:27], v5, s[36:39], s28 offen sc1
    buffer_load_dwordx4 v[28:31], v6, s[36:39], s28 offen sc1
    s_add_u32 s28, s26, 1024
    buffer_load_dwordx4 v[32:35], v5, s[36:39], s28 offen sc1
    buffer_load_dwordx4 v[36:39], v6, s[36:39], s28 offen sc1
    s_add_u32 s28, s26, 2048
    buffer_load_dwordx4 v[40:43], v5, s[36:39], s28 offen sc1
    buffer_load_dwordx4 v[44:47], v6, s[36:39], s28 offen sc1
    s_add_u32 s28, s26, 3072
    buffer_load_dwordx4 v[48:51], v5, s[36:39], s28 offen sc1
    buffer_load_dwordx4 v[52:55], v6, s[36:39], s28 offen sc1
    s_add_u32 s28, s26, 4096
    buffer_load_dwordx4 v[56:59], v5, s[36:39], s28 offen sc1
    buffer_load_dwordx4 v[60:63], v6, s[36:39], s28 offen sc1
    s_add_u32 s28, s26, 5120
    buffer_load_dwordx4 v[64:67], v5, s[36:39], s28 offen sc1
    buffer_load_dwordx4 v[68:71], v6, s[36:39], s28 offen sc1
    s_add_u32 s28, s26, 6144
    buffer_load_dwordx4 v[72:75], v5, s[36:39], s28 offen sc1
    buffer_load_dwordx4 v[76:79], v6, s[36:39], s28 offen sc1
    s_waitcnt vmcnt(14)
    ds_read_b64_tr_b16 v[8:9], v161 offset:0
    ds_read_b64_tr_b16 v[10:11], v161 offset:1024
    ds_read_b64_tr_b16 v[12:13], v162 offset:0
    ds_read_b64_tr_b16 v[14:15], v162 offset:1024
    s_add_u32 s28, s26, 7168
    buffer_load_dwordx4 v[80:83], v5, s[36:39], s28 offen sc1
    buffer_load_dwordx4 v[84:87], v6, s[36:39], s28 offen sc1
    ds_read_b64_tr_b16 v[16:17], v161 offset:2048
    ds_read_b64_tr_b16 v[18:19], v161 offset:3072
    ds_read_b64_tr_b16 v[20:21], v162 offset:2048
    ds_read_b64_tr_b16 v[22:23], v162 offset:3072
    s_waitcnt vmcnt(14)
C_uchk0:
    v_max3_u32 v7, v24, v25, v26
    v_max3_u32 v7, v7, v27, v28
    v_max3_u32 v7, v7, v29, v30
    v_max_u32 v7, v7, v31
    v_cmp_eq_u32 vcc, -1, v7
    s_waitcnt lgkmcnt(4)
    s_cbranch_vccnz C_uretry0
C_uok0:
    v_mfma_f32_32x32x16_bf16 v[96:111], v[8:11], v[24:27], 0
    v_mfma_f32_32x32x16_bf16 v[112:127], v[12:15], v[24:27], 0
    v_mfma_f32_32x32x16_bf16 v[128:143], v[8:11], v[28:31], 0
    v_mfma_f32_32x32x16_bf16 v[144:159], v[12:15], v[28:31], 0
    s_add_u32 m0, s27, 0
    s_nop 0
    buffer_load_dwordx4 v3, s[4:7], s20 offen lds
    buffer_load_dwordx4 v4, s[4:7], s20 offen offset:1024 lds
    s_add_u32 s20, s20, 16384
    s_add_u32 s28, s26, 8192
    buffer_load_dwordx4 v[24:27], v5, s[36:39], s28 offen sc1
    buffer_load_dwordx4 v[28:31], v6, s[36:39], s28 offen sc1
    ds_read_b64_tr_b16 v[8:9], v161 offset:4096
    ds_read_b64_tr_b16 v[10:11], v161 offset:5120
    ds_read_b64_tr_b16 v[12:13], v162 offset:4096
    ds_read_b64_tr_b16 v[14:15], v162 offset:5120
    s_waitcnt vmcnt(16)
C_uchk1:
    v_max3_u32 v7, v32, v33, v34
    v_max3_u32 v7, v7, v35, v36
    v_max3_u32 v7, v7, v37, v38
    v_max_u32 v7, v7, v39
    v_cmp_eq_u32 vcc, -1, v7
    s_waitcnt lgkmcnt(4)
    s_cbranch_vccnz C_uretry1
C_uok1:
    v_mfma_f32_32x32x16_bf16 v[96:111], v[16:19], v[32:35], v[96:111]
    v_mfma_f32_32x32x16_bf16 v[112:127], v[20:23], v[32:35], v[112:127]
    v_mfma_f32_32x32x16_bf16 v[128:143], v[16:19], v[36:39], v[128:143]
    v_mfma_f32_32x32x16_bf16 v[144:159], v[20:23], v[36:39], v[144:159]
    s_add_u32 m0, s27, 2048
    s_nop 0
    buffer_load_dwordx4 v3, s[4:7], s20 offen lds
    buffer_load_dwordx4 v4, s[4:7], s20 offen offset:1024 lds
    s_add_u32 s20, s20, 16384
    s_add_u32 s28, s26, 9216
    buffer_load_dwordx4 v[32:35], v5, s[36:39], s28 offen sc1
    buffer_load_dwordx4 v[36:39], v6, s[36:39], s28 offen sc1
    ds_read_b64_tr_b16 v[16:17], v161 offset:6144
    ds_read_b64_tr_b16 v[18:19], v161 offset:7168
    ds_read_b64_tr_b16 v[20:21], v162 offset:6144
    ds_read_b64_tr_b16 v[22:23], v162 offset:7168
    s_waitcnt vmcnt(18)
C_uchk2:
    v_max3_u32 v7, v40, v41, v42
    v_max3_u32 v7, v7, v43, v44
    v_max3_u32 v7, v7, v45, v46
    v_max_u32 v7, v7, v47
    v_cmp_eq_u32 vcc, -1, v7
    s_waitcnt lgkmcnt(4)
    s_cbranch_vccnz C_uretry2
C_uok2:
    v_mfma_f32_32x32x16_bf16 v[96:111], v[8:11], v[40:43], v[96:111]
    v_mfma_f32_32x32x16_bf16 v[112:127], v[12:15], v[40:43], v[112:127]
    v_mfma_f32_32x32x16_bf16 v[128:143], v[8:11], v[44:47], v[128:143]
    v_mfma_f32_32x32x16_bf16 v[144:159], v[12:15], v[44:47], v[144:159]
    s_add_u32 m0, s27, 4096
    s_nop 0
    buffer_load_dwordx4 v3, s[4:7], s20 offen lds
    buffer_load_dwordx4 v4, s[4:7], s20 offen offset:1024 lds
    s_add_u32 s20, s20, 16384
    s_add_u32 s28, s26, 10240
    s_cmp_eq_u32 s52, 3
    s_cmov_b32 s28, 0x40000000
    buffer_load_dwordx4 v[40:43], v5, s[36:39], s28 offen sc1
    buffer_load_dwordx4 v[44:47], v6, s[36:39], s28 offen sc1
    ds_read_b64_tr_b16 v[8:9], v161 offset:8192
    ds_read_b64_tr_b16 v[10:11], v161 offset:9216
    ds_read_b64_tr_b16 v[12:13], v162 offset:8192
    ds_read_b64_tr_b16 v[14:15], v162 offset:9216
    s_waitcnt vmcnt(20)
C_uchk3:
    v_max3_u32 v7, v48, v49, v50
    v_max3_u32 v7, v7, v51, v52
    v_max3_u32 v7, v7, v53, v54
    v_max_u32 v7, v7, v55
    v_cmp_eq_u32 vcc, -1, v7
    s_waitcnt lgkmcnt(4)
    s_cbranch_vccnz C_uretry3
C_uok3:
    v_mfma_f32_32x32x16_bf16 v[96:111], v[16:19], v[48:51], v[96:111]
    v_mfma_f32_32x32x16_bf16 v[112:127], v[20:23], v[48:51], v[112:127]
    v_mfma_f32_32x32x16_bf16 v[128:143], v[16:19], v[52:55], v[128:143]
    v_mfma_f32_32x32x16_bf16 v[144:159], v[20:23], v[52:55], v[144:159]
    s_add_u32 m0, s27, 6144
    s_nop 0
    buffer_load_dwordx4 v3, s[4:7], s20 offen lds
    buffer_load_dwordx4 v4, s[4:7], s20 offen offset:1024 lds
    s_add_u32 s20, s20, 16384
    s_add_u32 s28, s23, 0
    buffer_load_dwordx4 v[48:51], v5, s[36:39], s28 offen sc1
    buffer_load_dwordx4 v[52:55], v6, s[36:39], s28 offen sc1
    ds_read_b64_tr_b16 v[16:17], v161 offset:10240
    ds_read_b64_tr_b16 v[18:19], v161 offset:11264
    ds_read_b64_tr_b16 v[20:21], v162 offset:10240
    ds_read_b64_tr_b16 v[22:23], v162 offset:11264
    s_waitcnt vmcnt(22)
C_uchk4:
    v_max3_u32 v7, v56, v57, v58
    v_max3_u32 v7, v7, v59, v60
    v_max3_u32 v7, v7, v61, v62
    v_max_u32 v7, v7, v63
    v_cmp_eq_u32 vcc, -1, v7
    s_waitcnt lgkmcnt(4)
    s_cbranch_vccnz C_uretry4
C_uok4:
    v_mfma_f32_32x32x16_bf16 v[96:111], v[8:11], v[56:59], v[96:111]
    v_mfma_f32_32x32x16_bf16 v[112:127], v[12:15], v[56:59], v[112:127]
    v_mfma_f32_32x32x16_bf16 v[128:143], v[8:11], v[60:63], v[128:143]
    v_mfma_f32_32x32x16_bf16 v[144:159], v[12:15], v[60:63], v[144:159]
    s_add_u32 m0, s27, 8192
    s_nop 0
    buffer_load_dwordx4 v3, s[4:7], s20 offen lds
    buffer_load_dwordx4 v4, s[4:7], s20 offen offset:1024 lds
    s_add_u32 s20, s20, 16384
    s_add_u32 s28, s23, 1024
    buffer_load_dwordx4 v[56:59], v5, s[36:39], s28 offen sc1
    buffer_load_dwordx4 v[60:63], v6, s[36:39], s28 offen sc1
    ds_read_b64_tr_b16 v[8:9], v161 offset:12288
    ds_read_b64_tr_b16 v[10:11], v161 offset:13312
    ds_read_b64_tr_b16 v[12:13], v162 offset:12288
    ds_read_b64_tr_b16 v[14:15], v162 offset:13312
    s_waitcnt vmcnt(24)
C_uchk5:
    v_max3_u32 v7, v64, v65, v66
    v_max3_u32 v7, v7, v67, v68
    v_max3_u32 v7, v7, v69, v70
    v_max_u32 v7, v7, v71
    v_cmp_eq_u32 vcc, -1, v7
    s_waitcnt lgkmcnt(4)
    s_cbranch_vccnz C_uretry5
C_uok5:
    v_mfma_f32_32x32x16_bf16 v[96:111], v[16:19], v[64:67], v[96:111]
    v_mfma_f32_32x32x16_bf16 v[112:127], v[20:23], v[64:67], v[112:127]
    v_mfma_f32_32x32x16_bf16 v[128:143], v[16:19], v[68:71], v[128:143]
    v_mfma_f32_32x32x16_bf16 v[144:159], v[20:23], v[68:71], v[144:159]
    s_add_u32 m0, s27, 10240
    s_nop 0
    buffer_load_dwordx4 v3, s[4:7], s20 offen lds
    buffer_load_dwordx4 v4, s[4:7], s20 offen offset:1024 lds
    s_add_u32 s20, s20, 16384
    s_add_u32 s28, s23, 2048
    buffer_load_dwordx4 v[64:67], v5, s[36:39], s28 offen sc1
    buffer_load_dwordx4 v[68:71], v6, s[36:39], s28 offen sc1
    ds_read_b64_tr_b16 v[16:17], v161 offset:14336
    ds_read_b64_tr_b16 v[18:19], v161 offset:15360
    ds_read_b64_tr_b16 v[20:21], v162 offset:14336
    ds_read_b64_tr_b16 v[22:23], v162 offset:15360
    s_waitcnt vmcnt(26)
C_uchk6:
    v_max3_u32 v7, v72, v73, v74
    v_max3_u32 v7, v7, v75, v76
    v_max3_u32 v7, v7, v77, v78
    v_max_u32 v7, v7, v79
    v_cmp_eq_u32 vcc, -1, v7
    s_waitcnt lgkmcnt(4)
    s_cbranch_vccnz C_uretry6
C_uok6:
    v_mfma_f32_32x32x16_bf16 v[96:111], v[8:11], v[72:75], v[96:111]
    v_mfma_f32_32x32x16_bf16 v[112:127], v[12:15], v[72:75], v[112:127]
    v_mfma_f32_32x32x16_bf16 v[128:143], v[8:11], v[76:79], v[128:143]
    v_mfma_f32_32x32x16_bf16 v[144:159], v[12:15], v[76:79], v[144:159]
    s_add_u32 m0, s27, 12288
    s_nop 0
    buffer_load_dwordx4 v3, s[4:7], s20 offen lds
    buffer_load_dwordx4 v4, s[4:7], s20 offen offset:1024 lds
    s_add_u32 s20, s20, 16384
    s_add_u32 s28, s23, 3072
    buffer_load_dwordx4 v[72:75], v5, s[36:39], s28 offen sc1
    buffer_load_dwordx4 v[76:79], v6, s[36:39], s28 offen sc1
    ds_read_b64_tr_b16 v[8:9], v161 offset:16384
    ds_read_b64_tr_b16 v[10:11], v161 offset:17408
    ds_read_b64_tr_b16 v[12:13], v162 offset:16384
    ds_read_b64_tr_b16 v[14:15], v162 offset:17408
    s_waitcnt vmcnt(28)
C_uchk7:
    v_max3_u32 v7, v80, v81, v82
    v_max3_u32 v7, v7, v83, v84
    v_max3_u32 v7, v7, v85, v86
    v_max_u32 v7, v7, v87
    v_cmp_eq_u32 vcc, -1, v7
    s_waitcnt lgkmcnt(4)
    s_cbranch_vccnz C_uretry7
C_uok7:
    v_mfma_f32_32x32x16_bf16 v[96:111], v[16:19], v[80:83], v[96:111]
    v_mfma_f32_32x32x16_bf16 v[112:127], v[20:23], v[80:83], v[112:127]
    v_mfma_f32_32x32x16_bf16 v[128:143], v[16:19], v[84:87], v[128:143]
    v_mfma_f32_32x32x16_bf16 v[144:159], v[20:23], v[84:87], v[144:159]
    s_add_u32 m0, s27, 14336
    s_nop 0
    buffer_load_dwordx4 v3, s[4:7], s20 offen lds
    buffer_load_dwordx4 v4, s[4:7], s20 offen offset:1024 lds
    s_add_u32 s20, s20, 16384
    s_add_u32 s28, s23, 4096
    buffer_load_dwordx4 v[80:83], v5, s[36:39], s28 offen sc1
    buffer_load_dwordx4 v[84:87], v6, s[36:39], s28 offen sc1
    ds_read_b64_tr_b16 v[16:17], v161 offset:18432
    ds_read_b64_tr_b16 v[18:19], v161 offset:19456
    ds_read_b64_tr_b16 v[20:21], v162 offset:18432
    ds_read_b64_tr_b16 v[22:23], v162 offset:19456
    s_waitcnt vmcnt(28)
C_uchk8:
    v_max3_u32 v7, v24, v25, v26
    v_max3_u32 v7, v7, v27, v28
    v_max3_u32 v7, v7, v29, v30
    v_max_u32 v7, v7, v31
    v_cmp_eq_u32 vcc, -1, v7
    s_waitcnt lgkmcnt(4)
    s_cbranch_vccnz C_uretry8
C_uok8:
    v_mfma_f32_32x32x16_bf16 v[96:111], v[8:11], v[24:27], v[96:111]
    v_mfma_f32_32x32x16_bf16 v[112:127], v[12:15], v[24:27], v[112:127]
    v_mfma_f32_32x32x16_bf16 v[128:143], v[8:11], v[28:31], v[128:143]
    v_mfma_f32_32x32x16_bf16 v[144:159], v[12:15], v[28:31], v[144:159]
    s_add_u32 s28, s23, 5120
    buffer_load_dwordx4 v[24:27], v5, s[36:39], s28 offen sc1
    buffer_load_dwordx4 v[28:31], v6, s[36:39], s28 offen sc1
    ds_read_b64_tr_b16 v[8:9], v161 offset:20480
    ds_read_b64_tr_b16 v[10:11], v161 offset:21504
    ds_read_b64_tr_b16 v[12:13], v162 offset:20480
    ds_read_b64_tr_b16 v[14:15], v162 offset:21504
    s_waitcnt vmcnt(26)
C_uchk9:
    v_max3_u32 v7, v32, v33, v34
    v_max3_u32 v7, v7, v35, v36
    v_max3_u32 v7, v7, v37, v38
    v_max_u32 v7, v7, v39
    v_cmp_eq_u32 vcc, -1, v7
    s_waitcnt lgkmcnt(4)
    s_cbranch_vccnz C_uretry9
C_uok9:
    v_mfma_f32_32x32x16_bf16 v[96:111], v[16:19], v[32:35], v[96:111]
    v_mfma_f32_32x32x16_bf16 v[112:127], v[20:23], v[32:35], v[112:127]
    v_mfma_f32_32x32x16_bf16 v[128:143], v[16:19], v[36:39], v[128:143]
    v_mfma_f32_32x32x16_bf16 v[144:159], v[20:23], v[36:39], v[144:159]
    s_add_u32 s28, s23, 6144
    buffer_load_dwordx4 v[32:35], v5, s[36:39], s28 offen sc1
    buffer_load_dwordx4 v[36:39], v6, s[36:39], s28 offen sc1
    s_waitcnt vmcnt(34)
    ds_read_b64_tr_b16 v[16:17], v161 offset:0
    ds_read_b64_tr_b16 v[18:19], v161 offset:1024
    ds_read_b64_tr_b16 v[20:21], v162 offset:0
    ds_read_b64_tr_b16 v[22:23], v162 offset:1024
    s_waitcnt vmcnt(24)
C_uchk10:
    v_max3_u32 v7, v40, v41, v42
    v_max3_u32 v7, v7, v43, v44
    v_max3_u32 v7, v7, v45, v46
    v_max_u32 v7, v7, v47
    v_cmp_eq_u32 vcc, -1, v7
    s_waitcnt lgkmcnt(4)
    s_cbranch_vccnz C_uretry10
C_uok10:
    v_mfma_f32_32x32x16_bf16 v[96:111], v[8:11], v[40:43], v[96:111]
    v_mfma_f32_32x32x16_bf16 v[112:127], v[12:15], v[40:43], v[112:127]
    v_mfma_f32_32x32x16_bf16 v[128:143], v[8:11], v[44:47], v[128:143]
    v_mfma_f32_32x32x16_bf16 v[144:159], v[12:15], v[44:47], v[144:159]
    s_add_u32 s28, s23, 7168
    buffer_load_dwordx4 v[40:43], v5, s[36:39], s28 offen sc1
    buffer_load_dwordx4 v[44:47], v6, s[36:39], s28 offen sc1
    s_waitcnt vmcnt(32)
    ds_read_b64_tr_b16 v[8:9], v161 offset:2048
    ds_read_b64_tr_b16 v[10:11], v161 offset:3072
    ds_read_b64_tr_b16 v[12:13], v162 offset:2048
    ds_read_b64_tr_b16 v[14:15], v162 offset:3072
    s_waitcnt vmcnt(22)
C_uchk11:
    v_max3_u32 v7, v48, v49, v50
    v_max3_u32 v7, v7, v51, v52
    v_max3_u32 v7, v7, v53, v54
    v_max_u32 v7, v7, v55
    v_cmp_eq_u32 vcc, -1, v7
    s_waitcnt lgkmcnt(4)
    s_cbranch_vccnz C_uretry11
C_uok11:
    v_mfma_f32_32x32x16_bf16 v[96:111], v[16:19], v[48:51], v[96:111]
    v_mfma_f32_32x32x16_bf16 v[112:127], v[20:23], v[48:51], v[112:127]
    v_mfma_f32_32x32x16_bf16 v[128:143], v[16:19], v[52:55], v[128:143]
    v_mfma_f32_32x32x16_bf16 v[144:159], v[20:23], v[52:55], v[144:159]
    s_waitcnt vmcnt(28)
    ds_read_b64_tr_b16 v[16:17], v161 offset:4096
    ds_read_b64_tr_b16 v[18:19], v161 offset:5120
    ds_read_b64_tr_b16 v[20:21], v162 offset:4096
    ds_read_b64_tr_b16 v[22:23], v162 offset:5120
    s_waitcnt vmcnt(18)
C_uchk12:
    v_max3_u32 v7, v56, v57, v58
    v_max3_u32 v7, v7, v59, v60
    v_max3_u32 v7, v7, v61, v62
    v_max_u32 v7, v7, v63
    v_cmp_eq_u32 vcc, -1, v7
    s_waitcnt lgkmcnt(4)
    s_cbranch_vccnz C_uretry12
C_uok12:
    v_mfma_f32_32x32x16_bf16 v[96:111], v[8:11], v[56:59], v[96:111]
    v_mfma_f32_32x32x16_bf16 v[112:127], v[12:15], v[56:59], v[112:127]
    v_mfma_f32_32x32x16_bf16 v[128:143], v[8:11], v[60:63], v[128:143]
    v_mfma_f32_32x32x16_bf16 v[144:159], v[12:15], v[60:63], v[144:159]
    s_waitcnt vmcnt(24)
    ds_read_b64_tr_b16 v[8:9], v161 offset:6144
    ds_read_b64_tr_b16 v[10:11], v161 offset:7168
    ds_read_b64_tr_b16 v[12:13], v162 offset:6144
    ds_read_b64_tr_b16 v[14:15], v162 offset:7168
    s_waitcnt vmcnt(14)
C_uchk13:
    v_max3_u32 v7, v64, v65, v66
    v_max3_u32 v7, v7, v67, v68
    v_max3_u32 v7, v7, v69, v70
    v_max_u32 v7, v7, v71
    v_cmp_eq_u32 vcc, -1, v7
    s_waitcnt lgkmcnt(4)
    s_cbranch_vccnz C_uretry13
C_uok13:
    v_mfma_f32_32x32x16_bf16 v[96:111], v[16:19], v[64:67], v[96:111]
    v_mfma_f32_32x32x16_bf16 v[112:127], v[20:23], v[64:67], v[112:127]
    v_mfma_f32_32x32x16_bf16 v[128:143], v[16:19], v[68:71], v[128:143]
    v_mfma_f32_32x32x16_bf16 v[144:159], v[20:23], v[68:71], v[144:159]
    s_waitcnt vmcnt(20)
    ds_read_b64_tr_b16 v[16:17], v161 offset:8192
    ds_read_b64_tr_b16 v[18:19], v161 offset:9216
    ds_read_b64_tr_b16 v[20:21], v162 offset:8192
    ds_read_b64_tr_b16 v[22:23], v162 offset:9216
    s_waitcnt vmcnt(10)
C_uchk14:
    v_max3_u32 v7, v72, v73, v74
    v_max3_u32 v7, v7, v75, v76
    v_max3_u32 v7, v7, v77, v78
    v_max_u32 v7, v7, v79
    v_cmp_eq_u32 vcc, -1, v7
    s_waitcnt lgkmcnt(4)
    s_cbranch_vccnz C_uretry14
C_uok14:
    v_mfma_f32_32x32x16_bf16 v[96:111], v[8:11], v[72:75], v[96:111]
    v_mfma_f32_32x32x16_bf16 v[112:127], v[12:15], v[72:75], v[112:127]
    v_mfma_f32_32x32x16_bf16 v[128:143], v[8:11], v[76:79], v[128:143]
    v_mfma_f32_32x32x16_bf16 v[144:159], v[12:15], v[76:79], v[144:159]
    s_waitcnt vmcnt(16)
    ds_read_b64_tr_b16 v[8:9], v161 offset:10240
    ds_read_b64_tr_b16 v[10:11], v161 offset:11264
    ds_read_b64_tr_b16 v[12:13], v162 offset:10240
    ds_read_b64_tr_b16 v[14:15], v162 offset:11264
    s_waitcnt vmcnt(6)
C_uchk15:
    v_max3_u32 v7, v80, v81, v82
    v_max3_u32 v7, v7, v83, v84
    v_max3_u32 v7, v7, v85, v86
    v_max_u32 v7, v7, v87
    v_cmp_eq_u32 vcc, -1, v7
    s_waitcnt lgkmcnt(4)
    s_cbranch_vccnz C_uretry15
C_uok15:
    v_mfma_f32_32x32x16_bf16 v[96:111], v[16:19], v[80:83], v[96:111]
    v_mfma_f32_32x32x16_bf16 v[112:127], v[20:23], v[80:83], v[112:127]
    v_mfma_f32_32x32x16_bf16 v[128:143], v[16:19], v[84:87], v[128:143]
    v_mfma_f32_32x32x16_bf16 v[144:159], v[20:23], v[84:87], v[144:159]
    s_waitcnt vmcnt(12)
    ds_read_b64_tr_b16 v[16:17], v161 offset:12288
    ds_read_b64_tr_b16 v[18:19], v161 offset:13312
    ds_read_b64_tr_b16 v[20:21], v162 offset:12288
    ds_read_b64_tr_b16 v[22:23], v162 offset:13312
    s_waitcnt vmcnt(4)
C_uchk16:
    v_max3_u32 v7, v24, v25, v26
    v_max3_u32 v7, v7, v27, v28
    v_max3_u32 v7, v7, v29, v30
    v_max_u32 v7, v7, v31
    v_cmp_eq_u32 vcc, -1, v7
    s_waitcnt lgkmcnt(4)
    s_cbranch_vccnz C_uretry16
C_uok16:
    v_mfma_f32_32x32x16_bf16 v[96:111], v[8:11], v[24:27], v[96:111]
    v_mfma_f32_32x32x16_bf16 v[112:127], v[12:15], v[24:27], v[112:127]
    v_mfma_f32_32x32x16_bf16 v[128:143], v[8:11], v[28:31], v[128:143]
    v_mfma_f32_32x32x16_bf16 v[144:159], v[12:15], v[28:31], v[144:159]
    s_waitcnt vmcnt(8)
    ds_read_b64_tr_b16 v[8:9], v161 offset:14336
    ds_read_b64_tr_b16 v[10:11], v161 offset:15360
    ds_read_b64_tr_b16 v[12:13], v162 offset:14336
    ds_read_b64_tr_b16 v[14:15], v162 offset:15360
    s_waitcnt vmcnt(2)
C_uchk17:
    v_max3_u32 v7, v32, v33, v34
    v_max3_u32 v7, v7, v35, v36
    v_max3_u32 v7, v7, v37, v38
    v_max_u32 v7, v7, v39
    v_cmp_eq_u32 vcc, -1, v7
    s_waitcnt lgkmcnt(4)
    s_cbranch_vccnz C_uretry17
C_uok17:
    v_mfma_f32_32x32x16_bf16 v[96:111], v[16:19], v[32:35], v[96:111]
    v_mfma_f32_32x32x16_bf16 v[112:127], v[20:23], v[32:35], v[112:127]
    v_mfma_f32_32x32x16_bf16 v[128:143], v[16:19], v[36:39], v[128:143]
    v_mfma_f32_32x32x16_bf16 v[144:159], v[20:23], v[36:39], v[144:159]
    s_waitcnt vmcnt(0)
C_uchk18:
    v_max3_u32 v7, v40, v41, v42
    v_max3_u32 v7, v7, v43, v44
    v_max3_u32 v7, v7, v45, v46
    v_max_u32 v7, v7, v47
    v_cmp_eq_u32 vcc, -1, v7
    s_waitcnt lgkmcnt(0)
    s_cbranch_vccnz C_uretry18
C_uok18:
    v_mfma_f32_32x32x16_bf16 v[96:111], v[8:11], v[40:43], v[96:111]
    v_mfma_f32_32x32x16_bf16 v[112:127], v[12:15], v[40:43], v[112:127]
    v_mfma_f32_32x32x16_bf16 v[128:143], v[8:11], v[44:47], v[128:143]
    v_mfma_f32_32x32x16_bf16 v[144:159], v[12:15], v[44:47], v[144:159]
    s_branch C_udone
C_uretry0:
    s_sub_u32 s63, s63, 1
    s_cbranch_scc1 C_uok0
    s_waitcnt vmcnt(0)
    s_sleep 4
    s_add_u32 s28, s26, 0
    buffer_load_dwordx4 v[24:27], v5, s[36:39], s28 offen sc1
    buffer_load_dwordx4 v[28:31], v6, s[36:39], s28 offen sc1
    s_add_u32 s28, s26, 1024
    buffer_load_dwordx4 v[32:35], v5, s[36:39], s28 offen sc1
    buffer_load_dwordx4 v[36:39], v6, s[36:39], s28 offen sc1
    s_add_u32 s28, s26, 2048
    buffer_load_dwordx4 v[40:43], v5, s[36:39], s28 offen sc1
    buffer_load_dwordx4 v[44:47], v6, s[36:39], s28 offen sc1
    s_add_u32 s28, s26, 3072
    buffer_load_dwordx4 v[48:51], v5, s[36:39], s28 offen sc1
    buffer_load_dwordx4 v[52:55], v6, s[36:39], s28 offen sc1
    s_add_u32 s28, s26, 4096
    buffer_load_dwordx4 v[56:59], v5, s[36:39], s28 offen sc1
    buffer_load_dwordx4 v[60:63], v6, s[36:39], s28 offen sc1
    s_add_u32 s28, s26, 5120
    buffer_load_dwordx4 v[64:67], v5, s[36:39], s28 offen sc1
    buffer_load_dwordx4 v[68:71], v6, s[36:39], s28 offen sc1
    s_add_u32 s28, s26, 6144
    buffer_load_dwordx4 v[72:75], v5, s[36:39], s28 offen sc1
    buffer_load_dwordx4 v[76:79], v6, s[36:39], s28 offen sc1
    s_add_u32 s28, s26, 7168
    buffer_load_dwordx4 v[80:83], v5, s[36:39], s28 offen sc1
    buffer_load_dwordx4 v[84:87], v6, s[36:39], s28 offen sc1
    s_waitcnt vmcnt(0)
    s_branch C_uchk0
C_uretry1:
    s_sub_u32 s63, s63, 1
    s_cbranch_scc1 C_uok1
    s_waitcnt vmcnt(0)
    s_sleep 4
    s_add_u32 s28, s26, 1024
    buffer_load_dwordx4 v[32:35], v5, s[36:39], s28 offen sc1
    buffer_load_dwordx4 v[36:39], v6, s[36:39], s28 offen sc1
    s_add_u32 s28, s26, 2048
    buffer_load_dwordx4 v[40:43], v5, s[36:39], s28 offen sc1
    buffer_load_dwordx4 v[44:47], v6, s[36:39], s28 offen sc1
    s_add_u32 s28, s26, 3072
    buffer_load_dwordx4 v[48:51], v5, s[36:39], s28 offen sc1
    buffer_load_dwordx4 v[52:55], v6, s[36:39], s28 offen sc1
    s_add_u32 s28, s26, 4096
    buffer_load_dwordx4 v[56:59], v5, s[36:39], s28 offen sc1
    buffer_load_dwordx4 v[60:63], v6, s[36:39], s28 offen sc1
    s_add_u32 s28, s26, 5120
    buffer_load_dwordx4 v[64:67], v5, s[36:39], s28 offen sc1
    buffer_load_dwordx4 v[68:71], v6, s[36:39], s28 offen sc1
    s_add_u32 s28, s26, 6144
    buffer_load_dwordx4 v[72:75], v5, s[36:39], s28 offen sc1
    buffer_load_dwordx4 v[76:79], v6, s[36:39], s28 offen sc1
    s_add_u32 s28, s26, 7168
    buffer_load_dwordx4 v[80:83], v5, s[36:39], s28 offen sc1
    buffer_load_dwordx4 v[84:87], v6, s[36:39], s28 offen sc1
    s_add_u32 s28, s26, 8192
    buffer_load_dwordx4 v[24:27], v5, s[36:39], s28 offen sc1
    buffer_load_dwordx4 v[28:31], v6, s[36:39], s28 offen sc1
    s_waitcnt vmcnt(0)
    s_branch C_uchk1
C_uretry2:
    s_sub_u32 s63, s63, 1
    s_cbranch_scc1 C_uok2
    s_waitcnt vmcnt(0)
    s_sleep 4
    s_add_u32 s28, s26, 2048
    buffer_load_dwordx4 v[40:43], v5, s[36:39], s28 offen sc1
    buffer_load_dwordx4 v[44:47], v6, s[36:39], s28 offen sc1
    s_add_u32 s28, s26, 3072
    buffer_load_dwordx4 v[48:51], v5, s[36:39], s28 offen sc1
    buffer_load_dwordx4 v[52:55], v6, s[36:39], s28 offen sc1
    s_add_u32 s28, s26, 4096
    buffer_load_dwordx4 v[56:59], v5, s[36:39], s28 offen sc1
    buffer_load_dwordx4 v[60:63], v6, s[36:39], s28 offen sc1
    s_add_u32 s28, s26, 5120
    buffer_load_dwordx4 v[64:67], v5, s[36:39], s28 offen sc1
    buffer_load_dwordx4 v[68:71], v6, s[36:39], s28 offen sc1
    s_add_u32 s28, s26, 6144
    buffer_load_dwordx4 v[72:75], v5, s[36:39], s28 offen sc1
    buffer_load_dwordx4 v[76:79], v6, s[36:39], s28 offen sc1
    s_add_u32 s28, s26, 7168
    buffer_load_dwordx4 v[80:83], v5, s[36:39], s28 offen sc1
    buffer_load_dwordx4 v[84:87], v6, s[36:39], s28 offen sc1
    s_add_u32 s28, s26, 8192
    buffer_load_dwordx4 v[24:27], v5, s[36:39], s28 offen sc1
    buffer_load_dwordx4 v[28:31], v6, s[36:39], s28 offen sc1
    s_add_u32 s28, s26, 9216
    buffer_load_dwordx4 v[32:35], v5, s[36:39], s28 offen sc1
    buffer_load_dwordx4 v[36:39], v6, s[36:39], s28 offen sc1
    s_waitcnt vmcnt(0)
    s_branch C_uchk2
C_uretry3:
    s_sub_u32 s63, s63, 1
    s_cbranch_scc1 C_uok3
    s_waitcnt vmcnt(0)
    s_sleep 4
    s_add_u32 s28, s26, 3072
    buffer_load_dwordx4 v[48:51], v5, s[36:39], s28 offen sc1
    buffer_load_dwordx4 v[52:55], v6, s[36:39], s28 offen sc1
    s_add_u32 s28, s26, 4096
    buffer_load_dwordx4 v[56:59], v5, s[36:39], s28 offen sc1
    buffer_load_dwordx4 v[60:63], v6, s[36:39], s28 offen sc1
    s_add_u32 s28, s26, 5120
    buffer_load_dwordx4 v[64:67], v5, s[36:39], s28 offen sc1
    buffer_load_dwordx4 v[68:71], v6, s[36:39], s28 offen sc1
    s_add_u32 s28, s26, 6144
    buffer_load_dwordx4 v[72:75], v5, s[36:39], s28 offen sc1
    buffer_load_dwordx4 v[76:79], v6, s[36:39], s28 offen sc1
    s_add_u32 s28, s26, 7168
    buffer_load_dwordx4 v[80:83], v5, s[36:39], s28 offen sc1
    buffer_load_dwordx4 v[84:87], v6, s[36:39], s28 offen sc1
    s_add_u32 s28, s26, 8192
    buffer_load_dwordx4 v[24:27], v5, s[36:39], s28 offen sc1
    buffer_load_dwordx4 v[28:31], v6, s[36:39], s28 offen sc1
    s_add_u32 s28, s26, 9216
    buffer_load_dwordx4 v[32:35], v5, s[36:39], s28 offen sc1
    buffer_load_dwordx4 v[36:39], v6, s[36:39], s28 offen sc1
    s_add_u32 s28, s26, 10240
    s_cmp_eq_u32 s52, 3
    s_cmov_b32 s28, 0x40000000
    buffer_load_dwordx4 v[40:43], v5, s[36:39], s28 offen sc1
    buffer_load_dwordx4 v[44:47], v6, s[36:39], s28 offen sc1
    s_waitcnt vmcnt(0)
    s_branch C_uchk3
C_uretry4:
    s_sub_u32 s63, s63, 1
    s_cbranch_scc1 C_uok4
    s_waitcnt vmcnt(0)
    s_sleep 4
    s_add_u32 s28, s26, 4096
    buffer_load_dwordx4 v[56:59], v5, s[36:39], s28 offen sc1
    buffer_load_dwordx4 v[60:63], v6, s[36:39], s28 offen sc1
    s_add_u32 s28, s26, 5120
    buffer_load_dwordx4 v[64:67], v5, s[36:39], s28 offen sc1
    buffer_load_dwordx4 v[68:71], v6, s[36:39], s28 offen sc1
    s_add_u32 s28, s26, 6144
    buffer_load_dwordx4 v[72:75], v5, s[36:39], s28 offen sc1
    buffer_load_dwordx4 v[76:79], v6, s[36:39], s28 offen sc1
    s_add_u32 s28, s26, 7168
    buffer_load_dwordx4 v[80:83], v5, s[36:39], s28 offen sc1
    buffer_load_dwordx4 v[84:87], v6, s[36:39], s28 offen sc1
    s_add_u32 s28, s26, 8192
    buffer_load_dwordx4 v[24:27], v5, s[36:39], s28 offen sc1
    buffer_load_dwordx4 v[28:31], v6, s[36:39], s28 offen sc1
    s_add_u32 s28, s26, 9216
    buffer_load_dwordx4 v[32:35], v5, s[36:39], s28 offen sc1
    buffer_load_dwordx4 v[36:39], v6, s[36:39], s28 offen sc1
    s_add_u32 s28, s26, 10240
    s_cmp_eq_u32 s52, 3
    s_cmov_b32 s28, 0x40000000
    buffer_load_dwordx4 v[40:43], v5, s[36:39], s28 offen sc1
    buffer_load_dwordx4 v[44:47], v6, s[36:39], s28 offen sc1
    s_add_u32 s28, s23, 0
    buffer_load_dwordx4 v[48:51], v5, s[36:39], s28 offen sc1
    buffer_load_dwordx4 v[52:55], v6, s[36:39], s28 offen sc1
    s_waitcnt vmcnt(0)
    s_branch C_uchk4
C_uretry5:
    s_sub_u32 s63, s63, 1
    s_cbranch_scc1 C_uok5
    s_waitcnt vmcnt(0)
    s_sleep 4
    s_add_u32 s28, s26, 5120
    buffer_load_dwordx4 v[64:67], v5, s[36:39], s28 offen sc1
    buffer_load_dwordx4 v[68:71], v6, s[36:39], s28 offen sc1
    s_add_u32 s28, s26, 6144
    buffer_load_dwordx4 v[72:75], v5, s[36:39], s28 offen sc1
    buffer_load_dwordx4 v[76:79], v6, s[36:39], s28 offen sc1
    s_add_u32 s28, s26, 7168
    buffer_load_dwordx4 v[80:83], v5, s[36:39], s28 offen sc1
    buffer_load_dwordx4 v[84:87], v6, s[36:39], s28 offen sc1
    s_add_u32 s28, s26, 8192
    buffer_load_dwordx4 v[24:27], v5, s[36:39], s28 offen sc1
    buffer_load_dwordx4 v[28:31], v6, s[36:39], s28 offen sc1
    s_add_u32 s28, s26, 9216
    buffer_load_dwordx4 v[32:35], v5, s[36:39], s28 offen sc1
    buffer_load_dwordx4 v[36:39], v6, s[36:39], s28 offen sc1
    s_add_u32 s28, s26, 10240
    s_cmp_eq_u32 s52, 3
    s_cmov_b32 s28, 0x40000000
    buffer_load_dwordx4 v[40:43], v5, s[36:39], s28 offen sc1
    buffer_load_dwordx4 v[44:47], v6, s[36:39], s28 offen sc1
    s_add_u32 s28, s23, 0
    buffer_load_dwordx4 v[48:51], v5, s[36:39], s28 offen sc1
    buffer_load_dwordx4 v[52:55], v6, s[36:39], s28 offen sc1
    s_add_u32 s28, s23, 1024
    buffer_load_dwordx4 v[56:59], v5, s[36:39], s28 offen sc1
    buffer_load_dwordx4 v[60:63], v6, s[36:39], s28 offen sc1
    s_waitcnt vmcnt(0)
    s_branch C_uchk5
C_uretry6:
    s_sub_u32 s63, s63, 1
    s_cbranch_scc1 C_uok6
    s_waitcnt vmcnt(0)
    s_sleep 4
    s_add_u32 s28, s26, 6144
    buffer_load_dwordx4 v[72:75], v5, s[36:39], s28 offen sc1
    buffer_load_dwordx4 v[76:79], v6, s[36:39], s28 offen sc1
    s_add_u32 s28, s26, 7168
    buffer_load_dwordx4 v[80:83], v5, s[36:39], s28 offen sc1
    buffer_load_dwordx4 v[84:87], v6, s[36:39], s28 offen sc1
    s_add_u32 s28, s26, 8192
    buffer_load_dwordx4 v[24:27], v5, s[36:39], s28 offen sc1
    buffer_load_dwordx4 v[28:31], v6, s[36:39], s28 offen sc1
    s_add_u32 s28, s26, 9216
    buffer_load_dwordx4 v[32:35], v5, s[36:39], s28 offen sc1
    buffer_load_dwordx4 v[36:39], v6, s[36:39], s28 offen sc1
    s_add_u32 s28, s26, 10240
    s_cmp_eq_u32 s52, 3
    s_cmov_b32 s28, 0x40000000
    buffer_load_dwordx4 v[40:43], v5, s[36:39], s28 offen sc1
    buffer_load_dwordx4 v[44:47], v6, s[36:39], s28 offen sc1
    s_add_u32 s28, s23, 0
    buffer_load_dwordx4 v[48:51], v5, s[36:39], s28 offen sc1
    buffer_load_dwordx4 v[52:55], v6, s[36:39], s28 offen sc1
    s_add_u32 s28, s23, 1024
    buffer_load_dwordx4 v[56:59], v5, s[36:39], s28 offen sc1
    buffer_load_dwordx4 v[60:63], v6, s[36:39], s28 offen sc1
    s_add_u32 s28, s23, 2048
    buffer_load_dwordx4 v[64:67], v5, s[36:39], s28 offen sc1
    buffer_load_dwordx4 v[68:71], v6, s[36:39], s28 offen sc1
    s_waitcnt vmcnt(0)
    s_branch C_uchk6
C_uretry7:
    s_sub_u32 s63, s63, 1
    s_cbranch_scc1 C_uok7
    s_waitcnt vmcnt(0)
    s_sleep 4
    s_add_u32 s28, s26, 7168
    buffer_load_dwordx4 v[80:83], v5, s[36:39], s28 offen sc1
    buffer_load_dwordx4 v[84:87], v6, s[36:39], s28 offen sc1
    s_add_u32 s28, s26, 8192
    buffer_load_dwordx4 v[24:27], v5, s[36:39], s28 offen sc1
    buffer_load_dwordx4 v[28:31], v6, s[36:39], s28 offen sc1
    s_add_u32 s28, s26, 9216
    buffer_load_dwordx4 v[32:35], v5, s[36:39], s28 offen sc1
    buffer_load_dwordx4 v[36:39], v6, s[36:39], s28 offen sc1
    s_add_u32 s28, s26, 10240
    s_cmp_eq_u32 s52, 3
    s_cmov_b32 s28, 0x40000000
    buffer_load_dwordx4 v[40:43], v5, s[36:39], s28 offen sc1
    buffer_load_dwordx4 v[44:47], v6, s[36:39], s28 offen sc1
    s_add_u32 s28, s23, 0
    buffer_load_dwordx4 v[48:51], v5, s[36:39], s28 offen sc1
    buffer_load_dwordx4 v[52:55], v6, s[36:39], s28 offen sc1
    s_add_u32 s28, s23, 1024
    buffer_load_dwordx4 v[56:59], v5, s[36:39], s28 offen sc1
    buffer_load_dwordx4 v[60:63], v6, s[36:39], s28 offen sc1
    s_add_u32 s28, s23, 2048
    buffer_load_dwordx4 v[64:67], v5, s[36:39], s28 offen sc1
    buffer_load_dwordx4 v[68:71], v6, s[36:39], s28 offen sc1
    s_add_u32 s28, s23, 3072
    buffer_load_dwordx4 v[72:75], v5, s[36:39], s28 offen sc1
    buffer_load_dwordx4 v[76:79], v6, s[36:39], s28 offen sc1
    s_waitcnt vmcnt(0)
    s_branch C_uchk7
C_uretry8:
    s_sub_u32 s63, s63, 1
    s_cbranch_scc1 C_uok8
    s_waitcnt vmcnt(0)
    s_sleep 4
    s_add_u32 s28, s26, 8192
    buffer_load_dwordx4 v[24:27], v5, s[36:39], s28 offen sc1
    buffer_load_dwordx4 v[28:31], v6, s[36:39], s28 offen sc1
    s_add_u32 s28, s26, 9216
    buffer_load_dwordx4 v[32:35], v5, s[36:39], s28 offen sc1
    buffer_load_dwordx4 v[36:39], v6, s[36:39], s28 offen sc1
    s_add_u32 s28, s26, 10240
    s_cmp_eq_u32 s52, 3
    s_cmov_b32 s28, 0x40000000
    buffer_load_dwordx4 v[40:43], v5, s[36:39], s28 offen sc1
    buffer_load_dwordx4 v[44:47], v6, s[36:39], s28 offen sc1
    s_add_u32 s28, s23, 0
    buffer_load_dwordx4 v[48:51], v5, s[36:39], s28 offen sc1
    buffer_load_dwordx4 v[52:55], v6, s[36:39], s28 offen sc1
    s_add_u32 s28, s23, 1024
    buffer_load_dwordx4 v[56:59], v5, s[36:39], s28 offen sc1
    buffer_load_dwordx4 v[60:63], v6, s[36:39], s28 offen sc1
    s_add_u32 s28, s23, 2048
    buffer_load_dwordx4 v[64:67], v5, s[36:39], s28 offen sc1
    buffer_load_dwordx4 v[68:71], v6, s[36:39], s28 offen sc1
    s_add_u32 s28, s23, 3072
    buffer_load_dwordx4 v[72:75], v5, s[36:39], s28 offen sc1
    buffer_load_dwordx4 v[76:79], v6, s[36:39], s28 offen sc1
    s_add_u32 s28, s23, 4096
    buffer_load_dwordx4 v[80:83], v5, s[36:39], s28 offen sc1
    buffer_load_dwordx4 v[84:87], v6, s[36:39], s28 offen sc1
    s_waitcnt vmcnt(0)
    s_branch C_uchk8
C_uretry9:
    s_sub_u32 s63, s63, 1
    s_cbranch_scc1 C_uok9
    s_waitcnt vmcnt(0)
    s_sleep 4
    s_add_u32 s28, s26, 9216
    buffer_load_dwordx4 v[32:35], v5, s[36:39], s28 offen sc1
    buffer_load_dwordx4 v[36:39], v6, s[36:39], s28 offen sc1
    s_add_u32 s28, s26, 10240
    s_cmp_eq_u32 s52, 3
    s_cmov_b32 s28, 0x40000000
    buffer_load_dwordx4 v[40:43], v5, s[36:39], s28 offen sc1
    buffer_load_dwordx4 v[44:47], v6, s[36:39], s28 offen sc1
    s_add_u32 s28, s23, 0
    buffer_load_dwordx4 v[48:51], v5, s[36:39], s28 offen sc1
    buffer_load_dwordx4 v[52:55], v6, s[36:39], s28 offen sc1
    s_add_u32 s28, s23, 1024
    buffer_load_dwordx4 v[56:59], v5, s[36:39], s28 offen sc1
    buffer_load_dwordx4 v[60:63], v6, s[36:39], s28 offen sc1
    s_add_u32 s28, s23, 2048
    buffer_load_dwordx4 v[64:67], v5, s[36:39], s28 offen sc1
    buffer_load_dwordx4 v[68:71], v6, s[36:39], s28 offen sc1
    s_add_u32 s28, s23, 3072
    buffer_load_dwordx4 v[72:75], v5, s[36:39], s28 offen sc1
    buffer_load_dwordx4 v[76:79], v6, s[36:39], s28 offen sc1
    s_add_u32 s28, s23, 4096
    buffer_load_dwordx4 v[80:83], v5, s[36:39], s28 offen sc1
    buffer_load_dwordx4 v[84:87], v6, s[36:39], s28 offen sc1
    s_add_u32 s28, s23, 5120
    buffer_load_dwordx4 v[24:27], v5, s[36:39], s28 offen sc1
    buffer_load_dwordx4 v[28:31], v6, s[36:39], s28 offen sc1
    s_waitcnt vmcnt(0)
    s_branch C_uchk9
C_uretry10:
    s_sub_u32 s63, s63, 1
    s_cbranch_scc1 C_uok10
    s_waitcnt vmcnt(0)
    s_sleep 4
    s_add_u32 s28, s26, 10240
    s_cmp_eq_u32 s52, 3
    s_cmov_b32 s28, 0x40000000
    buffer_load_dwordx4 v[40:43], v5, s[36:39], s28 offen sc1
    buffer_load_dwordx4 v[44:47], v6, s[36:39], s28 offen sc1
    s_add_u32 s28, s23, 0
    buffer_load_dwordx4 v[48:51], v5, s[36:39], s28 offen sc1
    buffer_load_dwordx4 v[52:55], v6, s[36:39], s28 offen sc1
    s_add_u32 s28, s23, 1024
    buffer_load_dwordx4 v[56:59], v5, s[36:39], s28 offen sc1
    buffer_load_dwordx4 v[60:63], v6, s[36:39], s28 offen sc1
    s_add_u32 s28, s23, 2048
    buffer_load_dwordx4 v[64:67], v5, s[36:39], s28 offen sc1
    buffer_load_dwordx4 v[68:71], v6, s[36:39], s28 offen sc1
    s_add_u32 s28, s23, 3072
    buffer_load_dwordx4 v[72:75], v5, s[36:39], s28 offen sc1
    buffer_load_dwordx4 v[76:79], v6, s[36:39], s28 offen sc1
    s_add_u32 s28, s23, 4096
    buffer_load_dwordx4 v[80:83], v5, s[36:39], s28 offen sc1
    buffer_load_dwordx4 v[84:87], v6, s[36:39], s28 offen sc1
    s_add_u32 s28, s23, 5120
    buffer_load_dwordx4 v[24:27], v5, s[36:39], s28 offen sc1
    buffer_load_dwordx4 v[28:31], v6, s[36:39], s28 offen sc1
    s_add_u32 s28, s23, 6144
    buffer_load_dwordx4 v[32:35], v5, s[36:39], s28 offen sc1
    buffer_load_dwordx4 v[36:39], v6, s[36:39], s28 offen sc1
    s_waitcnt vmcnt(0)
    s_branch C_uchk10
C_uretry11:
    s_sub_u32 s63, s63, 1
    s_cbranch_scc1 C_uok11
    s_setprio 2
    v_mov_b32 v166, 162956
C_wc11:
    ds_read_b32 v167, v166
    s_waitcnt lgkmcnt(0)
    v_cmp_gt_u32 vcc, 4, v167
    s_nop 0
    s_cbranch_vccz C_wc11_ok
    s_sleep 4
    s_branch C_wc11
C_wc11_ok:
    s_waitcnt vmcnt(0)
    s_sleep 1
    s_add_u32 s28, s23, 0
    buffer_load_dwordx4 v[48:51], v5, s[36:39], s28 offen sc1
    buffer_load_dwordx4 v[52:55], v6, s[36:39], s28 offen sc1
    s_add_u32 s28, s23, 1024
    buffer_load_dwordx4 v[56:59], v5, s[36:39], s28 offen sc1
    buffer_load_dwordx4 v[60:63], v6, s[36:39], s28 offen sc1
    s_add_u32 s28, s23, 2048
    buffer_load_dwordx4 v[64:67], v5, s[36:39], s28 offen sc1
    buffer_load_dwordx4 v[68:71], v6, s[36:39], s28 offen sc1
    s_add_u32 s28, s23, 3072
    buffer_load_dwordx4 v[72:75], v5, s[36:39], s28 offen sc1
    buffer_load_dwordx4 v[76:79], v6, s[36:39], s28 offen sc1
    s_add_u32 s28, s23, 4096
    buffer_load_dwordx4 v[80:83], v5, s[36:39], s28 offen sc1
    buffer_load_dwordx4 v[84:87], v6, s[36:39], s28 offen sc1
    s_add_u32 s28, s23, 5120
    buffer_load_dwordx4 v[24:27], v5, s[36:39], s28 offen sc1
    buffer_load_dwordx4 v[28:31], v6, s[36:39], s28 offen sc1
    s_add_u32 s28, s23, 6144
    buffer_load_dwordx4 v[32:35], v5, s[36:39], s28 offen sc1
    buffer_load_dwordx4 v[36:39], v6, s[36:39], s28 offen sc1
    s_add_u32 s28, s23, 7168
    buffer_load_dwordx4 v[40:43], v5, s[36:39], s28 offen sc1
    buffer_load_dwordx4 v[44:47], v6, s[36:39], s28 offen sc1
    s_waitcnt vmcnt(0)
    s_branch C_uchk11
C_uretry12:
    s_sub_u32 s63, s63, 1
    s_cbranch_scc1 C_uok12
    s_setprio 2
    v_mov_b32 v166, 162956
C_wc12:
    ds_read_b32 v167, v166
    s_waitcnt lgkmcnt(0)
    v_cmp_gt_u32 vcc, 4, v167
    s_nop 0
    s_cbranch_vccz C_wc12_ok
    s_sleep 4
    s_branch C_wc12
C_wc12_ok:
    s_waitcnt vmcnt(0)
    s_sleep 1
    s_add_u32 s28, s23, 1024
    buffer_load_dwordx4 v[56:59], v5, s[36:39], s28 offen sc1
    buffer_load_dwordx4 v[60:63], v6, s[36:39], s28 offen sc1
    s_add_u32 s28, s23, 2048
    buffer_load_dwordx4 v[64:67], v5, s[36:39], s28 offen sc1
    buffer_load_dwordx4 v[68:71], v6, s[36:39], s28 offen sc1
    s_add_u32 s28, s23, 3072
    buffer_load_dwordx4 v[72:75], v5, s[36:39], s28 offen sc1
    buffer_load_dwordx4 v[76:79], v6, s[36:39], s28 offen sc1
    s_add_u32 s28, s23, 4096
    buffer_load_dwordx4 v[80:83], v5, s[36:39], s28 offen sc1
    buffer_load_dwordx4 v[84:87], v6, s[36:39], s28 offen sc1
    s_add_u32 s28, s23, 5120
    buffer_load_dwordx4 v[24:27], v5, s[36:39], s28 offen sc1
    buffer_load_dwordx4 v[28:31], v6, s[36:39], s28 offen sc1
    s_add_u32 s28, s23, 6144
    buffer_load_dwordx4 v[32:35], v5, s[36:39], s28 offen sc1
    buffer_load_dwordx4 v[36:39], v6, s[36:39], s28 offen sc1
    s_add_u32 s28, s23, 7168
    buffer_load_dwordx4 v[40:43], v5, s[36:39], s28 offen sc1
    buffer_load_dwordx4 v[44:47], v6, s[36:39], s28 offen sc1
    s_waitcnt vmcnt(0)
    s_branch C_uchk12
C_uretry13:
    s_sub_u32 s63, s63, 1
    s_cbranch_scc1 C_uok13
    s_setprio 2
    v_mov_b32 v166, 162956
C_wc13:
    ds_read_b32 v167, v166
    s_waitcnt lgkmcnt(0)
    v_cmp_gt_u32 vcc, 4, v167
    s_nop 0
    s_cbranch_vccz C_wc13_ok
    s_sleep 4
    s_branch C_wc13
C_wc13_ok:
    s_waitcnt vmcnt(0)
    s_sleep 1
    s_add_u32 s28, s23, 2048
    buffer_load_dwordx4 v[64:67], v5, s[36:39], s28 offen sc1
    buffer_load_dwordx4 v[68:71], v6, s[36:39], s28 offen sc1
    s_add_u32 s28, s23, 3072
    buffer_load_dwordx4 v[72:75], v5, s[36:39], s28 offen sc1
    buffer_load_dwordx4 v[76:79], v6, s[36:39], s28 offen sc1
    s_add_u32 s28, s23, 4096
    buffer_load_dwordx4 v[80:83], v5, s[36:39], s28 offen sc1
    buffer_load_dwordx4 v[84:87], v6, s[36:39], s28 offen sc1
    s_add_u32 s28, s23, 5120
    buffer_load_dwordx4 v[24:27], v5, s[36:39], s28 offen sc1
    buffer_load_dwordx4 v[28:31], v6, s[36:39], s28 offen sc1
    s_add_u32 s28, s23, 6144
    buffer_load_dwordx4 v[32:35], v5, s[36:39], s28 offen sc1
    buffer_load_dwordx4 v[36:39], v6, s[36:39], s28 offen sc1
    s_add_u32 s28, s23, 7168
    buffer_load_dwordx4 v[40:43], v5, s[36:39], s28 offen sc1
    buffer_load_dwordx4 v[44:47], v6, s[36:39], s28 offen sc1
    s_waitcnt vmcnt(0)
    s_branch C_uchk13
C_uretry14:
    s_sub_u32 s63, s63, 1
    s_cbranch_scc1 C_uok14
    s_setprio 2
    v_mov_b32 v166, 162956
C_wc14:
    ds_read_b32 v167, v166
    s_waitcnt lgkmcnt(0)
    v_cmp_gt_u32 vcc, 4, v167
    s_nop 0
    s_cbranch_vccz C_wc14_ok
    s_sleep 4
    s_branch C_wc14
C_wc14_ok:
    s_waitcnt vmcnt(0)
    s_sleep 1
    s_add_u32 s28, s23, 3072
    buffer_load_dwordx4 v[72:75], v5, s[36:39], s28 offen sc1
    buffer_load_dwordx4 v[76:79], v6, s[36:39], s28 offen sc1
    s_add_u32 s28, s23, 4096
    buffer_load_dwordx4 v[80:83], v5, s[36:39], s28 offen sc1
    buffer_load_dwordx4 v[84:87], v6, s[36:39], s28 offen sc1
    s_add_u32 s28, s23, 5120
    buffer_load_dwordx4 v[24:27], v5, s[36:39], s28 offen sc1
    buffer_load_dwordx4 v[28:31], v6, s[36:39], s28 offen sc1
    s_add_u32 s28, s23, 6144
    buffer_load_dwordx4 v[32:35], v5, s[36:39], s28 offen sc1
    buffer_load_dwordx4 v[36:39], v6, s[36:39], s28 offen sc1
    s_add_u32 s28, s23, 7168
    buffer_load_dwordx4 v[40:43], v5, s[36:39], s28 offen sc1
    buffer_load_dwordx4 v[44:47], v6, s[36:39], s28 offen sc1
    s_waitcnt vmcnt(0)
    s_branch C_uchk14
C_uretry15:
    s_sub_u32 s63, s63, 1
    s_cbranch_scc1 C_uok15
    s_setprio 2
    v_mov_b32 v166, 162956
C_wc15:
    ds_read_b32 v167, v166
    s_waitcnt lgkmcnt(0)
    v_cmp_gt_u32 vcc, 4, v167
    s_nop 0
    s_cbranch_vccz C_wc15_ok
    s_sleep 4
    s_branch C_wc15
C_wc15_ok:
    s_waitcnt vmcnt(0)
    s_sleep 1
    s_add_u32 s28, s23, 4096
    buffer_load_dwordx4 v[80:83], v5, s[36:39], s28 offen sc1
    buffer_load_dwordx4 v[84:87], v6, s[36:39], s28 offen sc1
    s_add_u32 s28, s23, 5120
    buffer_load_dwordx4 v[24:27], v5, s[36:39], s28 offen sc1
    buffer_load_dwordx4 v[28:31], v6, s[36:39], s28 offen sc1
    s_add_u32 s28, s23, 6144
    buffer_load_dwordx4 v[32:35], v5, s[36:39], s28 offen sc1
    buffer_load_dwordx4 v[36:39], v6, s[36:39], s28 offen sc1
    s_add_u32 s28, s23, 7168
    buffer_load_dwordx4 v[40:43], v5, s[36:39], s28 offen sc1
    buffer_load_dwordx4 v[44:47], v6, s[36:39], s28 offen sc1
    s_waitcnt vmcnt(0)
    s_branch C_uchk15
C_uretry16:
    s_sub_u32 s63, s63, 1
    s_cbranch_scc1 C_uok16
    s_setprio 2
    v_mov_b32 v166, 162956
C_wc16:
    ds_read_b32 v167, v166
    s_waitcnt lgkmcnt(0)
    v_cmp_gt_u32 vcc, 4, v167
    s_nop 0
    s_cbranch_vccz C_wc16_ok
    s_sleep 4
    s_branch C_wc16
C_wc16_ok:
    s_waitcnt vmcnt(0)
    s_sleep 1
    s_add_u32 s28, s23, 5120
    buffer_load_dwordx4 v[24:27], v5, s[36:39], s28 offen sc1
    buffer_load_dwordx4 v[28:31], v6, s[36:39], s28 offen sc1
    s_add_u32 s28, s23, 6144
    buffer_load_dwordx4 v[32:35], v5, s[36:39], s28 offen sc1
    buffer_load_dwordx4 v[36:39], v6, s[36:39], s28 offen sc1
    s_add_u32 s28, s23, 7168
    buffer_load_dwordx4 v[40:43], v5, s[36:39], s28 offen sc1
    buffer_load_dwordx4 v[44:47], v6, s[36:39], s28 offen sc1
    s_waitcnt vmcnt(0)
    s_branch C_uchk16
C_uretry17:
    s_sub_u32 s63, s63, 1
    s_cbranch_scc1 C_uok17
    s_setprio 2
    v_mov_b32 v166, 162956
C_wc17:
    ds_read_b32 v167, v166
    s_waitcnt lgkmcnt(0)
    v_cmp_gt_u32 vcc, 4, v167
    s_nop 0
    s_cbranch_vccz C_wc17_ok
    s_sleep 4
    s_branch C_wc17
C_wc17_ok:
    s_waitcnt vmcnt(0)
    s_sleep 1
    s_add_u32 s28, s23, 6144
    buffer_load_dwordx4 v[32:35], v5, s[36:39], s28 offen sc1
    buffer_load_dwordx4 v[36:39], v6, s[36:39], s28 offen sc1
    s_add_u32 s28, s23, 7168
    buffer_load_dwordx4 v[40:43], v5, s[36:39], s28 offen sc1
    buffer_load_dwordx4 v[44:47], v6, s[36:39], s28 offen sc1
    s_waitcnt vmcnt(0)
    s_branch C_uchk17
C_uretry18:
    s_sub_u32 s63, s63, 1
    s_cbranch_scc1 C_uok18
    s_setprio 2
    v_mov_b32 v166, 162956
C_wc18:
    ds_read_b32 v167, v166
    s_waitcnt lgkmcnt(0)
    v_cmp_gt_u32 vcc, 4, v167
    s_nop 0
    s_cbranch_vccz C_wc18_ok
    s_sleep 4
    s_branch C_wc18
C_wc18_ok:
    s_waitcnt vmcnt(0)
    s_sleep 1
    s_add_u32 s28, s23, 7168
    buffer_load_dwordx4 v[40:43], v5, s[36:39], s28 offen sc1
    buffer_load_dwordx4 v[44:47], v6, s[36:39], s28 offen sc1
    s_waitcnt vmcnt(0)
    s_branch C_uchk18
C_udone:
    s_setprio 2
    v_add_u32 v6, s27, v5
    s_lshl_b32 s21, s52, 12
    s_add_u32 s21, s21, 65536
    v_add_u32 v3, s21, v5
    s_mov_b32 s21, 0xffff0000
    v_permlane32_swap_b32 v88, v90
    v_permlane32_swap_b32 v89, v91
    v_permlane32_swap_b32 v92, v94
    v_permlane32_swap_b32 v93, v95
    v_lshlrev_b32 v24, 16, v88
    v_and_b32 v25, s21, v88
    v_lshlrev_b32 v26, 16, v89
    v_and_b32 v27, s21, v89
    v_lshlrev_b32 v28, 16, v90
    v_and_b32 v29, s21, v90
    v_lshlrev_b32 v30, 16, v91
    v_and_b32 v31, s21, v91
    v_lshlrev_b32 v32, 16, v92
    v_and_b32 v33, s21, v92
    v_lshlrev_b32 v34, 16, v93
    v_and_b32 v35, s21, v93
    v_lshlrev_b32 v36, 16, v94
    v_and_b32 v37, s21, v94
    v_lshlrev_b32 v38, 16, v95
    v_and_b32 v39, s21, v95
    s_cmp_eq_u32 s52, 0
    s_cbranch_scc1 C_own0
    ds_write_b128 v6, v[96:99] offset:0
    ds_write_b128 v6, v[100:103] offset:1024
    ds_write_b128 v6, v[104:107] offset:2048
    ds_write_b128 v6, v[108:111] offset:3072
    s_branch C_nx0
C_own0:
    v_pk_add_f32 v[8:9], v[24:25], v[96:97]
    v_pk_add_f32 v[10:11], v[26:27], v[98:99]
    v_pk_add_f32 v[12:13], v[28:29], v[100:101]
    v_pk_add_f32 v[14:15], v[30:31], v[102:103]
    v_pk_add_f32 v[16:17], v[32:33], v[104:105]
    v_pk_add_f32 v[18:19], v[34:35], v[106:107]
    v_pk_add_f32 v[20:21], v[36:37], v[108:109]
    v_pk_add_f32 v[22:23], v[38:39], v[110:111]
C_nx0:
    s_cmp_eq_u32 s52, 1
    s_cbranch_scc1 C_own1
    ds_write_b128 v6, v[112:115] offset:4096
    ds_write_b128 v6, v[116:119] offset:5120
    ds_write_b128 v6, v[120:123] offset:6144
    ds_write_b128 v6, v[124:127] offset:7168
    s_branch C_nx1
C_own1:
    v_pk_add_f32 v[8:9], v[24:25], v[112:113]
    v_pk_add_f32 v[10:11], v[26:27], v[114:115]
    v_pk_add_f32 v[12:13], v[28:29], v[116:117]
    v_pk_add_f32 v[14:15], v[30:31], v[118:119]
    v_pk_add_f32 v[16:17], v[32:33], v[120:121]
    v_pk_add_f32 v[18:19], v[34:35], v[122:123]
    v_pk_add_f32 v[20:21], v[36:37], v[124:125]
    v_pk_add_f32 v[22:23], v[38:39], v[126:127]
C_nx1:
    s_cmp_eq_u32 s52, 2
    s_cbranch_scc1 C_own2
    ds_write_b128 v6, v[128:131] offset:8192
    ds_write_b128 v6, v[132:135] offset:9216
    ds_write_b128 v6, v[136:139] offset:10240
    ds_write_b128 v6, v[140:143] offset:11264
    s_branch C_nx2
C_own2:
    v_pk_add_f32 v[8:9], v[24:25], v[128:129]
    v_pk_add_f32 v[10:11], v[26:27], v[130:131]
    v_pk_add_f32 v[12:13], v[28:29], v[132:133]
    v_pk_add_f32 v[14:15], v[30:31], v[134:135]
    v_pk_add_f32 v[16:17], v[32:33], v[136:137]
    v_pk_add_f32 v[18:19], v[34:35], v[138:139]
    v_pk_add_f32 v[20:21], v[36:37], v[140:141]
    v_pk_add_f32 v[22:23], v[38:39], v[142:143]
C_nx2:
    s_cmp_eq_u32 s52, 3
    s_cbranch_scc1 C_own3
    ds_write_b128 v6, v[144:147] offset:12288
    ds_write_b128 v6, v[148:151] offset:13312
    ds_write_b128 v6, v[152:155] offset:14336
    ds_write_b128 v6, v[156:159] offset:15360
    s_branch C_nx3
C_own3:
    v_pk_add_f32 v[8:9], v[24:25], v[144:145]
    v_pk_add_f32 v[10:11], v[26:27], v[146:147]
    v_pk_add_f32 v[12:13], v[28:29], v[148:149]
    v_pk_add_f32 v[14:15], v[30:31], v[150:151]
    v_pk_add_f32 v[16:17], v[32:33], v[152:153]
    v_pk_add_f32 v[18:19], v[34:35], v[154:155]
    v_pk_add_f32 v[20:21], v[36:37], v[156:157]
    v_pk_add_f32 v[22:23], v[38:39], v[158:159]
C_nx3:
    v_mov_b32 v167, 3
    ds_write_b32 v165, v167
G_sync3:
    ds_read_b32 v166, v164
    s_waitcnt lgkmcnt(0)
    v_cmp_gt_u32 vcc, 3, v166
    s_nop 0
    s_cbranch_vccz G_synced3
    s_sleep 1
    s_branch G_sync3
G_synced3:
    s_add_u32 s22, s52, 1
    s_and_b32 s22, s22, 3
    s_mul_i32 s22, s22, 22528
    v_add_u32 v6, s22, v3
    ds_read_b128 v[96:99], v6 offset:0
    ds_read_b128 v[100:103], v6 offset:1024
    ds_read_b128 v[104:107], v6 offset:2048
    ds_read_b128 v[108:111], v6 offset:3072
    s_add_u32 s22, s52, 2
    s_and_b32 s22, s22, 3
    s_mul_i32 s22, s22, 22528
    v_add_u32 v6, s22, v3
    ds_read_b128 v[112:115], v6 offset:0
    ds_read_b128 v[116:119], v6 offset:1024
    ds_read_b128 v[120:123], v6 offset:2048
    ds_read_b128 v[124:127], v6 offset:3072
    s_add_u32 s22, s52, 3
    s_and_b32 s22, s22, 3
    s_mul_i32 s22, s22, 22528
    v_add_u32 v6, s22, v3
    ds_read_b128 v[128:131], v6 offset:0
    ds_read_b128 v[132:135], v6 offset:1024
    ds_read_b128 v[136:139], v6 offset:2048
    ds_read_b128 v[140:143], v6 offset:3072
    s_waitcnt lgkmcnt(8)
    v_pk_add_f32 v[8:9], v[8:9], v[96:97]
    v_pk_add_f32 v[10:11], v[10:11], v[98:99]
    v_pk_add_f32 v[12:13], v[12:13], v[100:101]
    v_pk_add_f32 v[14:15], v[14:15], v[102:103]
    v_pk_add_f32 v[16:17], v[16:17], v[104:105]
    v_pk_add_f32 v[18:19], v[18:19], v[106:107]
    v_pk_add_f32 v[20:21], v[20:21], v[108:109]
    v_pk_add_f32 v[22:23], v[22:23], v[110:111]
    s_waitcnt lgkmcnt(4)
    v_pk_add_f32 v[8:9], v[8:9], v[112:113]
    v_pk_add_f32 v[10:11], v[10:11], v[114:115]
    v_pk_add_f32 v[12:13], v[12:13], v[116:117]
    v_pk_add_f32 v[14:15], v[14:15], v[118:119]
    v_pk_add_f32 v[16:17], v[16:17], v[120:121]
    v_pk_add_f32 v[18:19], v[18:19], v[122:123]
    v_pk_add_f32 v[20:21], v[20:21], v[124:125]
    v_pk_add_f32 v[22:23], v[22:23], v[126:127]
    s_waitcnt lgkmcnt(0)
    v_pk_add_f32 v[8:9], v[8:9], v[128:129]
    v_pk_add_f32 v[10:11], v[10:11], v[130:131]
    v_pk_add_f32 v[12:13], v[12:13], v[132:133]
    v_pk_add_f32 v[14:15], v[14:15], v[134:135]
    v_pk_add_f32 v[16:17], v[16:17], v[136:137]
    v_pk_add_f32 v[18:19], v[18:19], v[138:139]
    v_pk_add_f32 v[20:21], v[20:21], v[140:141]
    v_pk_add_f32 v[22:23], v[22:23], v[142:143]
    v_cvt_pk_bf16_f32 v88, v8, v9
    v_cvt_pk_bf16_f32 v89, v10, v11
    v_cvt_pk_bf16_f32 v90, v12, v13
    v_cvt_pk_bf16_f32 v91, v14, v15
    v_cvt_pk_bf16_f32 v92, v16, v17
    v_cvt_pk_bf16_f32 v93, v18, v19
    v_cvt_pk_bf16_f32 v94, v20, v21
    v_cvt_pk_bf16_f32 v95, v22, v23
    s_nop 1
    v_permlane32_swap_b32 v88, v90
    v_permlane32_swap_b32 v89, v91
    v_permlane32_swap_b32 v92, v94
    v_permlane32_swap_b32 v93, v95
    buffer_store_dwordx4 v[88:91], v160, s[44:47], s32 offen offset:0
    buffer_store_dwordx4 v[92:95], v160, s[44:47], s32 offen offset:32
    s_endpgm
.section .rodata,"a"
.p2align 6
.amdhsa_kernel parallel_sum__softmax_full_mha__mixer_gmlp__prompt_kernel
  .amdhsa_next_free_vgpr 168
  .amdhsa_next_free_sgpr 64
  .amdhsa_accum_offset 168
  .amdhsa_group_segment_fixed_size 0
  .amdhsa_kernarg_size 88
  .amdhsa_user_sgpr_count 2
  .amdhsa_user_sgpr_kernarg_segment_ptr 1
  .amdhsa_system_sgpr_workgroup_id_x 1
.end_amdhsa_kernel
```
